```python
import torch

def _softmax(x, axis=-1):
    return torch.softmax(x, dim=axis)
def _gelu(x):
    return torch.nn.functional.gelu(x, approximate="tanh")
def _silu(x):
    return torch.nn.functional.silu(x)
def _sigmoid(x):
    return torch.sigmoid(x)
def _layernorm(x, axis=-1, eps=1e-5):
    m = x.mean(dim=axis, keepdim=True)
    v = x.var(dim=axis, keepdim=True, unbiased=False)
    return (x - m) / torch.sqrt(v + eps)
def _scatter_add(tgt, idx, src, axis=0):
    return tgt.clone().index_add_(axis, idx, src)
def _segment_sum(src, seg, n):
    out = torch.zeros((n,) + src.shape[1:], dtype=src.dtype)
    return out.index_add_(0, seg, src)
def _pad(x, pw):
    flat = tuple(v for pair in reversed(pw) for v in pair)
    return torch.nn.functional.pad(x, flat)

kernel_name = 'standalone__softmax_full_bidir__decode'

def setup_inputs():

    _w = (lambda a: (lambda t: t.to(torch.bfloat16) if t.is_floating_point() else t)(torch.as_tensor(a)))
    B, H, Sq, Skv, Dh = 1, 32, 1, 65536, 128
    return {
        "q": _w((lambda *s: torch.randn(*s, dtype=torch.bfloat16) * 0.8)(B, H, Sq, Dh)),
        "k": _w((lambda *s: torch.randn(*s, dtype=torch.bfloat16) * 0.8)(B, H, Skv, Dh)),
        "v": _w((lambda *s: torch.randn(*s, dtype=torch.bfloat16) * 0.05)(B, H, Skv, Dh)),
    }

def reference(q, k, v):
    scale = q.shape[-1] ** -0.5
    scores = torch.einsum('bhqd,bhkd->bhqk', q, k) * scale
    attn = _softmax(scores, axis=-1)
    return torch.einsum('bhqk,bhkd->bhqd', attn, v)
```

```asm
; @launch grid=(256,1,1) block=(128,1,1) lds=1280
.amdgcn_target "amdgcn-amd-amdhsa--gfx950"
.text
.globl standalone__softmax_full_bidir__decode_kernel
.p2align 8
.type standalone__softmax_full_bidir__decode_kernel,@function
standalone__softmax_full_bidir__decode_kernel:
    s_cmp_ge_u32 s2, 256
    s_cbranch_scc1 L_end
    s_load_dwordx4 s[44:47], s[0:1], 0
    s_load_dwordx4 s[48:51], s[0:1], 16
    s_load_dwordx4 s[52:55], s[0:1], 32
    v_readfirstlane_b32 s37, v0
    v_and_b32 v0, 63, v0
    s_lshr_b32 s31, s2, 3
    s_and_b32 s32, s2, 7
    v_lshlrev_b32 v3, 4, v0
    s_lshl_b32 s35, s31, 8
    s_lshl_b32 s36, s31, 13
    s_mov_b32 s30, 0x3e0293ee
    s_mov_b32 s14, 0x2000
    s_mov_b32 s15, 0x00020000
    s_cmp_ge_u32 s37, 64
    s_cbranch_scc1 L_helper
    v_bfe_u32 v7, v0, 2, 2
    v_lshlrev_b32 v2, 8, v7
    v_lshrrev_b32 v7, 4, v0
    v_lshl_add_u32 v2, v7, 6, v2
    v_and_b32 v7, 3, v0
    v_lshl_add_u32 v2, v7, 4, v2
    v_and_b32 v7, 0xff, v2
    s_mov_b32 s28, 0
    s_bitcmp1_b32 s2, 0
    s_cselect_b32 s37, 0x145000, 0
    s_xor_b32 s28, s28, s37
    s_bitcmp1_b32 s2, 1
    s_cselect_b32 s37, 0x46000, 0
    s_xor_b32 s28, s28, s37
    s_bitcmp1_b32 s2, 2
    s_cselect_b32 s37, 0x101000, 0
    s_xor_b32 s28, s28, s37
    s_bitcmp1_b32 s2, 3
    s_cselect_b32 s37, 0x580000, 0
    s_xor_b32 s28, s28, s37
    s_bitcmp1_b32 s2, 4
    s_cselect_b32 s37, 0x402000, 0
    s_xor_b32 s28, s28, s37
    s_bitcmp1_b32 s2, 5
    s_cselect_b32 s37, 0x101000, 0
    s_xor_b32 s28, s28, s37
    s_bitcmp1_b32 s2, 6
    s_cselect_b32 s37, 0x763000, 0
    s_xor_b32 s28, s28, s37
    s_bitcmp1_b32 s2, 7
    s_cselect_b32 s37, 0x8000, 0
    s_xor_b32 s28, s28, s37
    s_mov_b32 s56, s28
    s_xor_b32 s57, s28, 0x10000
    s_xor_b32 s58, s28, 0x8000
    s_xor_b32 s59, s28, 0x18000
    s_mov_b32 s60, 0
    s_lshl_b32 s34, s31, 24
    s_mov_b32 s6, 0x1000000
    s_mov_b32 s7, 0x00020000
    s_mov_b32 s10, 0x1000000
    s_mov_b32 s11, 0x00020000
    s_mov_b32 s26, 0x100
    s_mov_b32 s27, 0x00020000
    s_waitcnt lgkmcnt(0)
    s_add_u32 s4, s46, s34
    s_addc_u32 s5, s47, 0
    buffer_load_dwordx4 v[64:67], v2, s[4:7], s56 offen nt
    buffer_load_dwordx4 v[68:71], v2, s[4:7], s56 offen offset:1024 nt
    buffer_load_dwordx4 v[72:75], v2, s[4:7], s56 offen offset:2048 nt
    buffer_load_dwordx4 v[76:79], v2, s[4:7], s56 offen offset:3072 nt
    s_add_u32 s24, s44, s35
    s_addc_u32 s25, s45, 0
    buffer_load_dwordx4 v[16:19], v7, s[24:27], 0 offen
    s_add_u32 s8, s48, s34
    s_addc_u32 s9, s49, 0
    buffer_load_dwordx4 v[80:83], v2, s[4:7], s57 offen nt
    buffer_load_dwordx4 v[84:87], v2, s[4:7], s57 offen offset:1024 nt
    buffer_load_dwordx4 v[88:91], v2, s[4:7], s57 offen offset:2048 nt
    buffer_load_dwordx4 v[92:95], v2, s[4:7], s57 offen offset:3072 nt
    buffer_load_dwordx4 v[96:99], v2, s[4:7], s58 offen nt
    buffer_load_dwordx4 v[100:103], v2, s[4:7], s58 offen offset:1024 nt
    buffer_load_dwordx4 v[104:107], v2, s[4:7], s58 offen offset:2048 nt
    buffer_load_dwordx4 v[108:111], v2, s[4:7], s58 offen offset:3072 nt
    buffer_load_dwordx4 v[112:115], v2, s[4:7], s59 offen nt
    buffer_load_dwordx4 v[116:119], v2, s[4:7], s59 offen offset:1024 nt
    buffer_load_dwordx4 v[120:123], v2, s[4:7], s59 offen offset:2048 nt
    buffer_load_dwordx4 v[124:127], v2, s[4:7], s59 offen offset:3072 nt
    buffer_load_dwordx4 v[128:131], v3, s[8:11], s56 offen nt
    buffer_load_dwordx4 v[132:135], v3, s[8:11], s56 offen offset:1024 nt
    buffer_load_dwordx4 v[136:139], v3, s[8:11], s56 offen offset:2048 nt
    buffer_load_dwordx4 v[140:143], v3, s[8:11], s56 offen offset:3072 nt
    buffer_load_dwordx4 v[144:147], v3, s[8:11], s57 offen nt
    buffer_load_dwordx4 v[148:151], v3, s[8:11], s57 offen offset:1024 nt
    buffer_load_dwordx4 v[152:155], v3, s[8:11], s57 offen offset:2048 nt
    buffer_load_dwordx4 v[156:159], v3, s[8:11], s57 offen offset:3072 nt
    s_add_u32 s12, s54, s36
    s_addc_u32 s13, s55, 0
    s_lshl_b32 s34, s32, 9
    s_lshl_b32 s37, s32, 7
    s_add_u32 s37, s37, 4096
    v_add_u32 v58, s34, v3
    v_subrev_u32 v7, 32, v0
    v_lshlrev_b32 v7, 16, v7
    v_add_u32 v7, s37, v7
    v_cmp_gt_u32 vcc, 32, v0
    s_nop 1
    v_cndmask_b32 v58, v7, v58, vcc
    s_mov_b32 s29, 3
    s_mov_b32 s61, 0
    s_mov_b32 s3, 0
    v_mov_b32 v59, 0
    s_mov_b32 s34, 0x202000
    v_writelane_b32 v59, s34, 0
    s_mov_b32 s34, 0x686000
    v_writelane_b32 v59, s34, 1
    s_mov_b32 s34, 0x6c6000
    v_writelane_b32 v59, s34, 2
    s_mov_b32 s34, 0xfc7000
    v_writelane_b32 v59, s34, 3
    s_mov_b32 s34, 0xbe7000
    v_writelane_b32 v59, s34, 4
    s_mov_b32 s34, 0xfef000
    v_writelane_b32 v59, s34, 5
    s_mov_b32 s34, 0xeef000
    v_writelane_b32 v59, s34, 6
    v_mov_b32 v4, 0xff800000
    v_mov_b32 v5, 0xff800000
    v_mov_b32 v6, 0
    v_mov_b32 v36, 0
    v_mov_b32 v37, 0
    v_mov_b32 v38, 0
    v_mov_b32 v39, 0
    v_mov_b32 v57, 1024
    v_and_b32 v7, 1, v0
    v_lshlrev_b32 v7, 4, v7
    v_mov_b32 v8, 0xffff
    v_lshlrev_b32 v8, v7, v8
    v_bfe_u32 v7, v0, 1, 3
    v_cmp_eq_u32 vcc, 0, v7
    s_nop 1
    v_cndmask_b32 v12, 0, v8, vcc
    v_cmp_eq_u32 vcc, 1, v7
    s_nop 1
    v_cndmask_b32 v13, 0, v8, vcc
    v_cmp_eq_u32 vcc, 2, v7
    s_nop 1
    v_cndmask_b32 v14, 0, v8, vcc
    v_cmp_eq_u32 vcc, 3, v7
    s_nop 1
    v_cndmask_b32 v15, 0, v8, vcc
    v_bfe_u32 v7, v0, 2, 2
    s_waitcnt vmcnt(20)
    v_cmp_eq_u32 vcc, 0, v7
    s_nop 1
    v_cndmask_b32 v20, 0, v16, vcc
    v_cndmask_b32 v21, 0, v17, vcc
    v_cndmask_b32 v22, 0, v18, vcc
    v_cndmask_b32 v23, 0, v19, vcc
    v_cmp_eq_u32 vcc, 1, v7
    s_nop 1
    v_cndmask_b32 v24, 0, v16, vcc
    v_cndmask_b32 v25, 0, v17, vcc
    v_cndmask_b32 v26, 0, v18, vcc
    v_cndmask_b32 v27, 0, v19, vcc
    v_cmp_eq_u32 vcc, 2, v7
    s_nop 1
    v_cndmask_b32 v28, 0, v16, vcc
    v_cndmask_b32 v29, 0, v17, vcc
    v_cndmask_b32 v30, 0, v18, vcc
    v_cndmask_b32 v31, 0, v19, vcc
    v_cmp_eq_u32 vcc, 3, v7
    s_nop 1
    v_cndmask_b32 v32, 0, v16, vcc
    v_cndmask_b32 v33, 0, v17, vcc
    v_cndmask_b32 v34, 0, v18, vcc
    v_cndmask_b32 v35, 0, v19, vcc
    s_waitcnt vmcnt(16)
    buffer_load_dwordx4 v[160:163], v3, s[8:11], s58 offen nt
    buffer_load_dwordx4 v[164:167], v3, s[8:11], s58 offen offset:1024 nt
    buffer_load_dwordx4 v[168:171], v3, s[8:11], s58 offen offset:2048 nt
    buffer_load_dwordx4 v[172:175], v3, s[8:11], s58 offen offset:3072 nt
    s_add_u32 s60, s60, 1
    s_ff1_i32_b32 s34, s60
    v_readlane_b32 s35, v59, s34
    buffer_load_dwordx4 v[176:179], v3, s[8:11], s59 offen nt
    buffer_load_dwordx4 v[180:183], v3, s[8:11], s59 offen offset:1024 nt
    buffer_load_dwordx4 v[184:187], v3, s[8:11], s59 offen offset:2048 nt
    buffer_load_dwordx4 v[188:191], v3, s[8:11], s59 offen offset:3072 nt
    s_xor_b32 s28, s28, s35
    s_mov_b32 s56, s28
    s_xor_b32 s57, s28, 0x10000
    s_xor_b32 s58, s28, 0x8000
    s_xor_b32 s59, s28, 0x18000
    v_mfma_f32_16x16x32_bf16 v[16:19], v[64:67], v[20:23], 0
    v_mfma_f32_16x16x32_bf16 v[16:19], v[68:71], v[24:27], v[16:19]
    v_mfma_f32_16x16x32_bf16 v[16:19], v[72:75], v[28:31], v[16:19]
    v_mfma_f32_16x16x32_bf16 v[16:19], v[76:79], v[32:35], v[16:19]
    s_nop 7
    v_mov_b32_dpp v7, v16 quad_perm:[0,0,0,0] row_mask:0xf bank_mask:0xf
    v_mov_b32_dpp v9, v18 quad_perm:[2,2,2,2] row_mask:0xf bank_mask:0xf
    s_nop 0
    v_add_f32_dpp v7, v17, v7 quad_perm:[1,1,1,1] row_mask:0xf bank_mask:0xf
    v_add_f32_dpp v9, v19, v9 quad_perm:[3,3,3,3] row_mask:0xf bank_mask:0xf
    v_add_f32 v192, v7, v9
    v_mfma_f32_16x16x32_bf16 v[16:19], v[80:83], v[20:23], 0
    v_mfma_f32_16x16x32_bf16 v[16:19], v[84:87], v[24:27], v[16:19]
    v_mfma_f32_16x16x32_bf16 v[16:19], v[88:91], v[28:31], v[16:19]
    v_mfma_f32_16x16x32_bf16 v[16:19], v[92:95], v[32:35], v[16:19]
    s_nop 7
    v_mov_b32_dpp v7, v16 quad_perm:[0,0,0,0] row_mask:0xf bank_mask:0xf
    v_mov_b32_dpp v9, v18 quad_perm:[2,2,2,2] row_mask:0xf bank_mask:0xf
    s_nop 0
    v_add_f32_dpp v7, v17, v7 quad_perm:[1,1,1,1] row_mask:0xf bank_mask:0xf
    v_add_f32_dpp v9, v19, v9 quad_perm:[3,3,3,3] row_mask:0xf bank_mask:0xf
    v_add_f32 v193, v7, v9
.p2align 6
L_loop:
    s_waitcnt vmcnt(16)
    buffer_load_dwordx4 v[64:67], v2, s[4:7], s56 offen nt
    buffer_load_dwordx4 v[68:71], v2, s[4:7], s56 offen offset:1024 nt
    buffer_load_dwordx4 v[72:75], v2, s[4:7], s56 offen offset:2048 nt
    buffer_load_dwordx4 v[76:79], v2, s[4:7], s56 offen offset:3072 nt
    s_waitcnt vmcnt(17)
    buffer_load_dwordx4 v[80:83], v2, s[4:7], s57 offen nt
    buffer_load_dwordx4 v[84:87], v2, s[4:7], s57 offen offset:1024 nt
    buffer_load_dwordx4 v[88:91], v2, s[4:7], s57 offen offset:2048 nt
    buffer_load_dwordx4 v[92:95], v2, s[4:7], s57 offen offset:3072 nt
    v_mfma_f32_16x16x32_bf16 v[16:19], v[96:99], v[20:23], 0
    v_mfma_f32_16x16x32_bf16 v[16:19], v[100:103], v[24:27], v[16:19]
    v_mfma_f32_16x16x32_bf16 v[16:19], v[104:107], v[28:31], v[16:19]
    v_mfma_f32_16x16x32_bf16 v[16:19], v[108:111], v[32:35], v[16:19]
    s_nop 7
    v_mov_b32_dpp v7, v16 quad_perm:[0,0,0,0] row_mask:0xf bank_mask:0xf
    v_mov_b32_dpp v9, v18 quad_perm:[2,2,2,2] row_mask:0xf bank_mask:0xf
    s_nop 0
    v_add_f32_dpp v7, v17, v7 quad_perm:[1,1,1,1] row_mask:0xf bank_mask:0xf
    v_add_f32_dpp v9, v19, v9 quad_perm:[3,3,3,3] row_mask:0xf bank_mask:0xf
    v_add_f32 v194, v7, v9
    v_mfma_f32_16x16x32_bf16 v[16:19], v[112:115], v[20:23], 0
    v_mfma_f32_16x16x32_bf16 v[16:19], v[116:119], v[24:27], v[16:19]
    v_mfma_f32_16x16x32_bf16 v[16:19], v[120:123], v[28:31], v[16:19]
    v_mfma_f32_16x16x32_bf16 v[16:19], v[124:127], v[32:35], v[16:19]
    v_max3_f32 v8, v192, v193, v194
    s_nop 6
    v_mov_b32_dpp v7, v16 quad_perm:[0,0,0,0] row_mask:0xf bank_mask:0xf
    v_mov_b32_dpp v9, v18 quad_perm:[2,2,2,2] row_mask:0xf bank_mask:0xf
    s_nop 0
    v_add_f32_dpp v7, v17, v7 quad_perm:[1,1,1,1] row_mask:0xf bank_mask:0xf
    v_add_f32_dpp v9, v19, v9 quad_perm:[3,3,3,3] row_mask:0xf bank_mask:0xf
    v_add_f32 v195, v7, v9
    v_max_f32 v7, v8, v195
    v_cmp_gt_f32 vcc, v7, v4
    s_cbranch_vccnz L_rare_m1
L_back_m1:
    v_fma_f32 v8, v192, s30, -v5
    v_exp_f32 v8, v8
    s_nop 0
    v_cvt_pk_bf16_f32 v56, v8, v8
    v_add_f32 v6, v6, v8
    s_nop 0
    v_and_b32_dpp v40, v56, v12 row_newbcast:0 row_mask:0xf bank_mask:0xf
    v_and_b32_dpp v41, v56, v13 row_newbcast:0 row_mask:0xf bank_mask:0xf
    v_and_b32_dpp v42, v56, v14 row_newbcast:0 row_mask:0xf bank_mask:0xf
    v_and_b32_dpp v43, v56, v15 row_newbcast:0 row_mask:0xf bank_mask:0xf
    v_and_b32_dpp v44, v56, v12 row_newbcast:4 row_mask:0xf bank_mask:0xf
    v_and_b32_dpp v45, v56, v13 row_newbcast:4 row_mask:0xf bank_mask:0xf
    v_and_b32_dpp v46, v56, v14 row_newbcast:4 row_mask:0xf bank_mask:0xf
    v_and_b32_dpp v47, v56, v15 row_newbcast:4 row_mask:0xf bank_mask:0xf
    s_waitcnt vmcnt(16)
    buffer_load_dwordx4 v[96:99], v2, s[4:7], s58 offen nt
    buffer_load_dwordx4 v[100:103], v2, s[4:7], s58 offen offset:1024 nt
    buffer_load_dwordx4 v[104:107], v2, s[4:7], s58 offen offset:2048 nt
    buffer_load_dwordx4 v[108:111], v2, s[4:7], s58 offen offset:3072 nt
    buffer_load_dwordx4 v[112:115], v2, s[4:7], s59 offen nt
    buffer_load_dwordx4 v[116:119], v2, s[4:7], s59 offen offset:1024 nt
    buffer_load_dwordx4 v[120:123], v2, s[4:7], s59 offen offset:2048 nt
    buffer_load_dwordx4 v[124:127], v2, s[4:7], s59 offen offset:3072 nt
    v_mfma_f32_16x16x32_bf16 v[36:39], v[40:43], v[128:131], v[36:39]
    v_and_b32_dpp v48, v56, v12 row_newbcast:8 row_mask:0xf bank_mask:0xf
    v_and_b32_dpp v49, v56, v13 row_newbcast:8 row_mask:0xf bank_mask:0xf
    v_and_b32_dpp v50, v56, v14 row_newbcast:8 row_mask:0xf bank_mask:0xf
    v_and_b32_dpp v51, v56, v15 row_newbcast:8 row_mask:0xf bank_mask:0xf
    v_mfma_f32_16x16x32_bf16 v[36:39], v[44:47], v[132:135], v[36:39]
    v_and_b32_dpp v52, v56, v12 row_newbcast:12 row_mask:0xf bank_mask:0xf
    v_and_b32_dpp v53, v56, v13 row_newbcast:12 row_mask:0xf bank_mask:0xf
    v_and_b32_dpp v54, v56, v14 row_newbcast:12 row_mask:0xf bank_mask:0xf
    v_and_b32_dpp v55, v56, v15 row_newbcast:12 row_mask:0xf bank_mask:0xf
    v_mfma_f32_16x16x32_bf16 v[36:39], v[48:51], v[136:139], v[36:39]
    s_nop 0
    v_mfma_f32_16x16x32_bf16 v[36:39], v[52:55], v[140:143], v[36:39]
    v_fma_f32 v8, v193, s30, -v5
    v_exp_f32 v8, v8
    s_nop 0
    v_cvt_pk_bf16_f32 v56, v8, v8
    v_add_f32 v6, v6, v8
    s_nop 0
    v_and_b32_dpp v40, v56, v12 row_newbcast:0 row_mask:0xf bank_mask:0xf
    v_and_b32_dpp v41, v56, v13 row_newbcast:0 row_mask:0xf bank_mask:0xf
    v_and_b32_dpp v42, v56, v14 row_newbcast:0 row_mask:0xf bank_mask:0xf
    v_and_b32_dpp v43, v56, v15 row_newbcast:0 row_mask:0xf bank_mask:0xf
    v_and_b32_dpp v44, v56, v12 row_newbcast:4 row_mask:0xf bank_mask:0xf
    v_and_b32_dpp v45, v56, v13 row_newbcast:4 row_mask:0xf bank_mask:0xf
    v_and_b32_dpp v46, v56, v14 row_newbcast:4 row_mask:0xf bank_mask:0xf
    v_and_b32_dpp v47, v56, v15 row_newbcast:4 row_mask:0xf bank_mask:0xf
    v_mfma_f32_16x16x32_bf16 v[36:39], v[40:43], v[144:147], v[36:39]
    v_and_b32_dpp v48, v56, v12 row_newbcast:8 row_mask:0xf bank_mask:0xf
    v_and_b32_dpp v49, v56, v13 row_newbcast:8 row_mask:0xf bank_mask:0xf
    v_and_b32_dpp v50, v56, v14 row_newbcast:8 row_mask:0xf bank_mask:0xf
    v_and_b32_dpp v51, v56, v15 row_newbcast:8 row_mask:0xf bank_mask:0xf
    v_mfma_f32_16x16x32_bf16 v[36:39], v[44:47], v[148:151], v[36:39]
    v_and_b32_dpp v52, v56, v12 row_newbcast:12 row_mask:0xf bank_mask:0xf
    v_and_b32_dpp v53, v56, v13 row_newbcast:12 row_mask:0xf bank_mask:0xf
    v_and_b32_dpp v54, v56, v14 row_newbcast:12 row_mask:0xf bank_mask:0xf
    v_and_b32_dpp v55, v56, v15 row_newbcast:12 row_mask:0xf bank_mask:0xf
    v_mfma_f32_16x16x32_bf16 v[36:39], v[48:51], v[152:155], v[36:39]
    s_nop 0
    v_mfma_f32_16x16x32_bf16 v[36:39], v[52:55], v[156:159], v[36:39]
    v_fma_f32 v8, v194, s30, -v5
    v_exp_f32 v8, v8
    s_nop 0
    v_cvt_pk_bf16_f32 v56, v8, v8
    v_add_f32 v6, v6, v8
    s_nop 0
    v_and_b32_dpp v40, v56, v12 row_newbcast:0 row_mask:0xf bank_mask:0xf
    v_and_b32_dpp v41, v56, v13 row_newbcast:0 row_mask:0xf bank_mask:0xf
    v_and_b32_dpp v42, v56, v14 row_newbcast:0 row_mask:0xf bank_mask:0xf
    v_and_b32_dpp v43, v56, v15 row_newbcast:0 row_mask:0xf bank_mask:0xf
    v_and_b32_dpp v44, v56, v12 row_newbcast:4 row_mask:0xf bank_mask:0xf
    v_and_b32_dpp v45, v56, v13 row_newbcast:4 row_mask:0xf bank_mask:0xf
    v_and_b32_dpp v46, v56, v14 row_newbcast:4 row_mask:0xf bank_mask:0xf
    v_and_b32_dpp v47, v56, v15 row_newbcast:4 row_mask:0xf bank_mask:0xf
    s_waitcnt vmcnt(16)
    buffer_load_dwordx4 v[128:131], v3, s[8:11], s56 offen nt
    buffer_load_dwordx4 v[132:135], v3, s[8:11], s56 offen offset:1024 nt
    buffer_load_dwordx4 v[136:139], v3, s[8:11], s56 offen offset:2048 nt
    buffer_load_dwordx4 v[140:143], v3, s[8:11], s56 offen offset:3072 nt
    s_waitcnt vmcnt(17)
    buffer_load_dwordx4 v[144:147], v3, s[8:11], s57 offen nt
    buffer_load_dwordx4 v[148:151], v3, s[8:11], s57 offen offset:1024 nt
    buffer_load_dwordx4 v[152:155], v3, s[8:11], s57 offen offset:2048 nt
    buffer_load_dwordx4 v[156:159], v3, s[8:11], s57 offen offset:3072 nt
    v_mfma_f32_16x16x32_bf16 v[36:39], v[40:43], v[160:163], v[36:39]
    v_and_b32_dpp v48, v56, v12 row_newbcast:8 row_mask:0xf bank_mask:0xf
    v_and_b32_dpp v49, v56, v13 row_newbcast:8 row_mask:0xf bank_mask:0xf
    v_and_b32_dpp v50, v56, v14 row_newbcast:8 row_mask:0xf bank_mask:0xf
    v_and_b32_dpp v51, v56, v15 row_newbcast:8 row_mask:0xf bank_mask:0xf
    v_mfma_f32_16x16x32_bf16 v[36:39], v[44:47], v[164:167], v[36:39]
    v_and_b32_dpp v52, v56, v12 row_newbcast:12 row_mask:0xf bank_mask:0xf
    v_and_b32_dpp v53, v56, v13 row_newbcast:12 row_mask:0xf bank_mask:0xf
    v_and_b32_dpp v54, v56, v14 row_newbcast:12 row_mask:0xf bank_mask:0xf
    v_and_b32_dpp v55, v56, v15 row_newbcast:12 row_mask:0xf bank_mask:0xf
    v_mfma_f32_16x16x32_bf16 v[36:39], v[48:51], v[168:171], v[36:39]
    s_nop 0
    v_mfma_f32_16x16x32_bf16 v[36:39], v[52:55], v[172:175], v[36:39]
    v_fma_f32 v8, v195, s30, -v5
    v_exp_f32 v8, v8
    s_nop 0
    v_cvt_pk_bf16_f32 v56, v8, v8
    v_add_f32 v6, v6, v8
    s_nop 0
    v_and_b32_dpp v40, v56, v12 row_newbcast:0 row_mask:0xf bank_mask:0xf
    v_and_b32_dpp v41, v56, v13 row_newbcast:0 row_mask:0xf bank_mask:0xf
    v_and_b32_dpp v42, v56, v14 row_newbcast:0 row_mask:0xf bank_mask:0xf
    v_and_b32_dpp v43, v56, v15 row_newbcast:0 row_mask:0xf bank_mask:0xf
    v_and_b32_dpp v44, v56, v12 row_newbcast:4 row_mask:0xf bank_mask:0xf
    v_and_b32_dpp v45, v56, v13 row_newbcast:4 row_mask:0xf bank_mask:0xf
    v_and_b32_dpp v46, v56, v14 row_newbcast:4 row_mask:0xf bank_mask:0xf
    v_and_b32_dpp v47, v56, v15 row_newbcast:4 row_mask:0xf bank_mask:0xf
    v_mfma_f32_16x16x32_bf16 v[36:39], v[40:43], v[176:179], v[36:39]
    v_and_b32_dpp v48, v56, v12 row_newbcast:8 row_mask:0xf bank_mask:0xf
    v_and_b32_dpp v49, v56, v13 row_newbcast:8 row_mask:0xf bank_mask:0xf
    v_and_b32_dpp v50, v56, v14 row_newbcast:8 row_mask:0xf bank_mask:0xf
    v_and_b32_dpp v51, v56, v15 row_newbcast:8 row_mask:0xf bank_mask:0xf
    v_mfma_f32_16x16x32_bf16 v[36:39], v[44:47], v[180:183], v[36:39]
    v_and_b32_dpp v52, v56, v12 row_newbcast:12 row_mask:0xf bank_mask:0xf
    v_and_b32_dpp v53, v56, v13 row_newbcast:12 row_mask:0xf bank_mask:0xf
    v_and_b32_dpp v54, v56, v14 row_newbcast:12 row_mask:0xf bank_mask:0xf
    v_and_b32_dpp v55, v56, v15 row_newbcast:12 row_mask:0xf bank_mask:0xf
    v_mfma_f32_16x16x32_bf16 v[36:39], v[48:51], v[184:187], v[36:39]
    s_nop 0
    v_mfma_f32_16x16x32_bf16 v[36:39], v[52:55], v[188:191], v[36:39]
    s_waitcnt vmcnt(16)
    buffer_load_dwordx4 v[160:163], v3, s[8:11], s58 offen nt
    buffer_load_dwordx4 v[164:167], v3, s[8:11], s58 offen offset:1024 nt
    buffer_load_dwordx4 v[168:171], v3, s[8:11], s58 offen offset:2048 nt
    buffer_load_dwordx4 v[172:175], v3, s[8:11], s58 offen offset:3072 nt
    s_add_u32 s60, s60, 1
    s_ff1_i32_b32 s34, s60
    v_readlane_b32 s35, v59, s34
    buffer_load_dwordx4 v[176:179], v3, s[8:11], s59 offen nt
    buffer_load_dwordx4 v[180:183], v3, s[8:11], s59 offen offset:1024 nt
    buffer_load_dwordx4 v[184:187], v3, s[8:11], s59 offen offset:2048 nt
    buffer_load_dwordx4 v[188:191], v3, s[8:11], s59 offen offset:3072 nt
    s_xor_b32 s28, s28, s35
    s_mov_b32 s56, s28
    s_xor_b32 s57, s28, 0x10000
    s_xor_b32 s58, s28, 0x8000
    s_xor_b32 s59, s28, 0x18000
    s_cmp_le_u32 s29, 3
    s_cbranch_scc1 L_hook
L_hook_back:
    v_mfma_f32_16x16x32_bf16 v[16:19], v[64:67], v[20:23], 0
    v_mfma_f32_16x16x32_bf16 v[16:19], v[68:71], v[24:27], v[16:19]
    v_mfma_f32_16x16x32_bf16 v[16:19], v[72:75], v[28:31], v[16:19]
    v_mfma_f32_16x16x32_bf16 v[16:19], v[76:79], v[32:35], v[16:19]
    s_nop 7
    v_mov_b32_dpp v7, v16 quad_perm:[0,0,0,0] row_mask:0xf bank_mask:0xf
    v_mov_b32_dpp v9, v18 quad_perm:[2,2,2,2] row_mask:0xf bank_mask:0xf
    s_nop 0
    v_add_f32_dpp v7, v17, v7 quad_perm:[1,1,1,1] row_mask:0xf bank_mask:0xf
    v_add_f32_dpp v9, v19, v9 quad_perm:[3,3,3,3] row_mask:0xf bank_mask:0xf
    v_add_f32 v192, v7, v9
    v_mfma_f32_16x16x32_bf16 v[16:19], v[80:83], v[20:23], 0
    v_mfma_f32_16x16x32_bf16 v[16:19], v[84:87], v[24:27], v[16:19]
    v_mfma_f32_16x16x32_bf16 v[16:19], v[88:91], v[28:31], v[16:19]
    v_mfma_f32_16x16x32_bf16 v[16:19], v[92:95], v[32:35], v[16:19]
    s_nop 7
    v_mov_b32_dpp v7, v16 quad_perm:[0,0,0,0] row_mask:0xf bank_mask:0xf
    v_mov_b32_dpp v9, v18 quad_perm:[2,2,2,2] row_mask:0xf bank_mask:0xf
    s_nop 0
    v_add_f32_dpp v7, v17, v7 quad_perm:[1,1,1,1] row_mask:0xf bank_mask:0xf
    v_add_f32_dpp v9, v19, v9 quad_perm:[3,3,3,3] row_mask:0xf bank_mask:0xf
    v_add_f32 v193, v7, v9
    s_sub_u32 s29, s29, 1
    s_cmp_lg_u32 s29, 0
    s_cbranch_scc1 L_loop
    s_cmp_eq_u32 s61, 0
    s_cbranch_scc1 L_main
L_dyn:
    s_waitcnt lgkmcnt(0)
    v_readfirstlane_b32 s28, v10
    v_readfirstlane_b32 s34, v11
    s_cmp_lt_i32 s34, 0
    s_cbranch_scc1 L_drain
    s_mov_b32 s56, s28
    s_xor_b32 s57, s28, 0x10000
    s_xor_b32 s58, s28, 0x8000
    s_xor_b32 s59, s28, 0x18000
    s_lshr_b32 s60, s34, 8
    s_and_b32 s29, s34, 127
    s_bitcmp1_b32 s34, 7
    s_cbranch_scc1 L_body_l
L_body_d:
    s_waitcnt vmcnt(20)
    buffer_load_dwordx4 v[64:67], v2, s[4:7], s56 offen nt
    buffer_load_dwordx4 v[68:71], v2, s[4:7], s56 offen offset:1024 nt
    buffer_load_dwordx4 v[72:75], v2, s[4:7], s56 offen offset:2048 nt
    buffer_load_dwordx4 v[76:79], v2, s[4:7], s56 offen offset:3072 nt
    buffer_load_dwordx4 v[80:83], v2, s[4:7], s57 offen nt
    buffer_load_dwordx4 v[84:87], v2, s[4:7], s57 offen offset:1024 nt
    buffer_load_dwordx4 v[88:91], v2, s[4:7], s57 offen offset:2048 nt
    buffer_load_dwordx4 v[92:95], v2, s[4:7], s57 offen offset:3072 nt
    v_mfma_f32_16x16x32_bf16 v[16:19], v[96:99], v[20:23], 0
    v_mfma_f32_16x16x32_bf16 v[16:19], v[100:103], v[24:27], v[16:19]
    v_mfma_f32_16x16x32_bf16 v[16:19], v[104:107], v[28:31], v[16:19]
    v_mfma_f32_16x16x32_bf16 v[16:19], v[108:111], v[32:35], v[16:19]
    s_nop 7
    v_mov_b32_dpp v7, v16 quad_perm:[0,0,0,0] row_mask:0xf bank_mask:0xf
    v_mov_b32_dpp v9, v18 quad_perm:[2,2,2,2] row_mask:0xf bank_mask:0xf
    s_nop 0
    v_add_f32_dpp v7, v17, v7 quad_perm:[1,1,1,1] row_mask:0xf bank_mask:0xf
    v_add_f32_dpp v9, v19, v9 quad_perm:[3,3,3,3] row_mask:0xf bank_mask:0xf
    v_add_f32 v194, v7, v9
    s_waitcnt vmcnt(24)
    v_mfma_f32_16x16x32_bf16 v[16:19], v[112:115], v[20:23], 0
    v_mfma_f32_16x16x32_bf16 v[16:19], v[116:119], v[24:27], v[16:19]
    v_mfma_f32_16x16x32_bf16 v[16:19], v[120:123], v[28:31], v[16:19]
    v_mfma_f32_16x16x32_bf16 v[16:19], v[124:127], v[32:35], v[16:19]
    v_max3_f32 v8, v192, v193, v194
    s_nop 6
    v_mov_b32_dpp v7, v16 quad_perm:[0,0,0,0] row_mask:0xf bank_mask:0xf
    v_mov_b32_dpp v9, v18 quad_perm:[2,2,2,2] row_mask:0xf bank_mask:0xf
    s_nop 0
    v_add_f32_dpp v7, v17, v7 quad_perm:[1,1,1,1] row_mask:0xf bank_mask:0xf
    v_add_f32_dpp v9, v19, v9 quad_perm:[3,3,3,3] row_mask:0xf bank_mask:0xf
    v_add_f32 v195, v7, v9
    v_max_f32 v7, v8, v195
    v_cmp_gt_f32 vcc, v7, v4
    s_cbranch_vccnz L_rare_d1
L_back_d1:
    v_fma_f32 v8, v192, s30, -v5
    v_exp_f32 v8, v8
    s_nop 0
    v_cvt_pk_bf16_f32 v56, v8, v8
    v_add_f32 v6, v6, v8
    s_nop 0
    v_and_b32_dpp v40, v56, v12 row_newbcast:0 row_mask:0xf bank_mask:0xf
    v_and_b32_dpp v41, v56, v13 row_newbcast:0 row_mask:0xf bank_mask:0xf
    v_and_b32_dpp v42, v56, v14 row_newbcast:0 row_mask:0xf bank_mask:0xf
    v_and_b32_dpp v43, v56, v15 row_newbcast:0 row_mask:0xf bank_mask:0xf
    v_and_b32_dpp v44, v56, v12 row_newbcast:4 row_mask:0xf bank_mask:0xf
    v_and_b32_dpp v45, v56, v13 row_newbcast:4 row_mask:0xf bank_mask:0xf
    v_and_b32_dpp v46, v56, v14 row_newbcast:4 row_mask:0xf bank_mask:0xf
    v_and_b32_dpp v47, v56, v15 row_newbcast:4 row_mask:0xf bank_mask:0xf
    s_waitcnt vmcnt(20)
    buffer_load_dwordx4 v[96:99], v2, s[4:7], s58 offen nt
    buffer_load_dwordx4 v[100:103], v2, s[4:7], s58 offen offset:1024 nt
    buffer_load_dwordx4 v[104:107], v2, s[4:7], s58 offen offset:2048 nt
    buffer_load_dwordx4 v[108:111], v2, s[4:7], s58 offen offset:3072 nt
    buffer_load_dwordx4 v[112:115], v2, s[4:7], s59 offen nt
    buffer_load_dwordx4 v[116:119], v2, s[4:7], s59 offen offset:1024 nt
    buffer_load_dwordx4 v[120:123], v2, s[4:7], s59 offen offset:2048 nt
    buffer_load_dwordx4 v[124:127], v2, s[4:7], s59 offen offset:3072 nt
    v_mfma_f32_16x16x32_bf16 v[36:39], v[40:43], v[128:131], v[36:39]
    v_and_b32_dpp v48, v56, v12 row_newbcast:8 row_mask:0xf bank_mask:0xf
    v_and_b32_dpp v49, v56, v13 row_newbcast:8 row_mask:0xf bank_mask:0xf
    v_and_b32_dpp v50, v56, v14 row_newbcast:8 row_mask:0xf bank_mask:0xf
    v_and_b32_dpp v51, v56, v15 row_newbcast:8 row_mask:0xf bank_mask:0xf
    v_mfma_f32_16x16x32_bf16 v[36:39], v[44:47], v[132:135], v[36:39]
    v_and_b32_dpp v52, v56, v12 row_newbcast:12 row_mask:0xf bank_mask:0xf
    v_and_b32_dpp v53, v56, v13 row_newbcast:12 row_mask:0xf bank_mask:0xf
    v_and_b32_dpp v54, v56, v14 row_newbcast:12 row_mask:0xf bank_mask:0xf
    v_and_b32_dpp v55, v56, v15 row_newbcast:12 row_mask:0xf bank_mask:0xf
    v_mfma_f32_16x16x32_bf16 v[36:39], v[48:51], v[136:139], v[36:39]
    s_nop 0
    v_mfma_f32_16x16x32_bf16 v[36:39], v[52:55], v[140:143], v[36:39]
    v_fma_f32 v8, v193, s30, -v5
    v_exp_f32 v8, v8
    s_nop 0
    v_cvt_pk_bf16_f32 v56, v8, v8
    v_add_f32 v6, v6, v8
    s_nop 0
    v_and_b32_dpp v40, v56, v12 row_newbcast:0 row_mask:0xf bank_mask:0xf
    v_and_b32_dpp v41, v56, v13 row_newbcast:0 row_mask:0xf bank_mask:0xf
    v_and_b32_dpp v42, v56, v14 row_newbcast:0 row_mask:0xf bank_mask:0xf
    v_and_b32_dpp v43, v56, v15 row_newbcast:0 row_mask:0xf bank_mask:0xf
    v_and_b32_dpp v44, v56, v12 row_newbcast:4 row_mask:0xf bank_mask:0xf
    v_and_b32_dpp v45, v56, v13 row_newbcast:4 row_mask:0xf bank_mask:0xf
    v_and_b32_dpp v46, v56, v14 row_newbcast:4 row_mask:0xf bank_mask:0xf
    v_and_b32_dpp v47, v56, v15 row_newbcast:4 row_mask:0xf bank_mask:0xf
    s_waitcnt vmcnt(24)
    v_mfma_f32_16x16x32_bf16 v[36:39], v[40:43], v[144:147], v[36:39]
    v_and_b32_dpp v48, v56, v12 row_newbcast:8 row_mask:0xf bank_mask:0xf
    v_and_b32_dpp v49, v56, v13 row_newbcast:8 row_mask:0xf bank_mask:0xf
    v_and_b32_dpp v50, v56, v14 row_newbcast:8 row_mask:0xf bank_mask:0xf
    v_and_b32_dpp v51, v56, v15 row_newbcast:8 row_mask:0xf bank_mask:0xf
    v_mfma_f32_16x16x32_bf16 v[36:39], v[44:47], v[148:151], v[36:39]
    v_and_b32_dpp v52, v56, v12 row_newbcast:12 row_mask:0xf bank_mask:0xf
    v_and_b32_dpp v53, v56, v13 row_newbcast:12 row_mask:0xf bank_mask:0xf
    v_and_b32_dpp v54, v56, v14 row_newbcast:12 row_mask:0xf bank_mask:0xf
    v_and_b32_dpp v55, v56, v15 row_newbcast:12 row_mask:0xf bank_mask:0xf
    v_mfma_f32_16x16x32_bf16 v[36:39], v[48:51], v[152:155], v[36:39]
    s_nop 0
    v_mfma_f32_16x16x32_bf16 v[36:39], v[52:55], v[156:159], v[36:39]
    v_fma_f32 v8, v194, s30, -v5
    v_exp_f32 v8, v8
    s_nop 0
    v_cvt_pk_bf16_f32 v56, v8, v8
    v_add_f32 v6, v6, v8
    s_nop 0
    v_and_b32_dpp v40, v56, v12 row_newbcast:0 row_mask:0xf bank_mask:0xf
    v_and_b32_dpp v41, v56, v13 row_newbcast:0 row_mask:0xf bank_mask:0xf
    v_and_b32_dpp v42, v56, v14 row_newbcast:0 row_mask:0xf bank_mask:0xf
    v_and_b32_dpp v43, v56, v15 row_newbcast:0 row_mask:0xf bank_mask:0xf
    v_and_b32_dpp v44, v56, v12 row_newbcast:4 row_mask:0xf bank_mask:0xf
    v_and_b32_dpp v45, v56, v13 row_newbcast:4 row_mask:0xf bank_mask:0xf
    v_and_b32_dpp v46, v56, v14 row_newbcast:4 row_mask:0xf bank_mask:0xf
    v_and_b32_dpp v47, v56, v15 row_newbcast:4 row_mask:0xf bank_mask:0xf
    s_waitcnt vmcnt(20)
    buffer_load_dwordx4 v[128:131], v3, s[8:11], s56 offen nt
    buffer_load_dwordx4 v[132:135], v3, s[8:11], s56 offen offset:1024 nt
    buffer_load_dwordx4 v[136:139], v3, s[8:11], s56 offen offset:2048 nt
    buffer_load_dwordx4 v[140:143], v3, s[8:11], s56 offen offset:3072 nt
    buffer_load_dwordx4 v[144:147], v3, s[8:11], s57 offen nt
    buffer_load_dwordx4 v[148:151], v3, s[8:11], s57 offen offset:1024 nt
    buffer_load_dwordx4 v[152:155], v3, s[8:11], s57 offen offset:2048 nt
    buffer_load_dwordx4 v[156:159], v3, s[8:11], s57 offen offset:3072 nt
    v_mfma_f32_16x16x32_bf16 v[36:39], v[40:43], v[160:163], v[36:39]
    v_and_b32_dpp v48, v56, v12 row_newbcast:8 row_mask:0xf bank_mask:0xf
    v_and_b32_dpp v49, v56, v13 row_newbcast:8 row_mask:0xf bank_mask:0xf
    v_and_b32_dpp v50, v56, v14 row_newbcast:8 row_mask:0xf bank_mask:0xf
    v_and_b32_dpp v51, v56, v15 row_newbcast:8 row_mask:0xf bank_mask:0xf
    v_mfma_f32_16x16x32_bf16 v[36:39], v[44:47], v[164:167], v[36:39]
    v_and_b32_dpp v52, v56, v12 row_newbcast:12 row_mask:0xf bank_mask:0xf
    v_and_b32_dpp v53, v56, v13 row_newbcast:12 row_mask:0xf bank_mask:0xf
    v_and_b32_dpp v54, v56, v14 row_newbcast:12 row_mask:0xf bank_mask:0xf
    v_and_b32_dpp v55, v56, v15 row_newbcast:12 row_mask:0xf bank_mask:0xf
    v_mfma_f32_16x16x32_bf16 v[36:39], v[48:51], v[168:171], v[36:39]
    s_nop 0
    v_mfma_f32_16x16x32_bf16 v[36:39], v[52:55], v[172:175], v[36:39]
    v_fma_f32 v8, v195, s30, -v5
    v_exp_f32 v8, v8
    s_nop 0
    v_cvt_pk_bf16_f32 v56, v8, v8
    v_add_f32 v6, v6, v8
    s_nop 0
    v_and_b32_dpp v40, v56, v12 row_newbcast:0 row_mask:0xf bank_mask:0xf
    v_and_b32_dpp v41, v56, v13 row_newbcast:0 row_mask:0xf bank_mask:0xf
    v_and_b32_dpp v42, v56, v14 row_newbcast:0 row_mask:0xf bank_mask:0xf
    v_and_b32_dpp v43, v56, v15 row_newbcast:0 row_mask:0xf bank_mask:0xf
    v_and_b32_dpp v44, v56, v12 row_newbcast:4 row_mask:0xf bank_mask:0xf
    v_and_b32_dpp v45, v56, v13 row_newbcast:4 row_mask:0xf bank_mask:0xf
    v_and_b32_dpp v46, v56, v14 row_newbcast:4 row_mask:0xf bank_mask:0xf
    v_and_b32_dpp v47, v56, v15 row_newbcast:4 row_mask:0xf bank_mask:0xf
    s_waitcnt vmcnt(24)
    v_mfma_f32_16x16x32_bf16 v[36:39], v[40:43], v[176:179], v[36:39]
    v_and_b32_dpp v48, v56, v12 row_newbcast:8 row_mask:0xf bank_mask:0xf
    v_and_b32_dpp v49, v56, v13 row_newbcast:8 row_mask:0xf bank_mask:0xf
    v_and_b32_dpp v50, v56, v14 row_newbcast:8 row_mask:0xf bank_mask:0xf
    v_and_b32_dpp v51, v56, v15 row_newbcast:8 row_mask:0xf bank_mask:0xf
    v_mfma_f32_16x16x32_bf16 v[36:39], v[44:47], v[180:183], v[36:39]
    v_and_b32_dpp v52, v56, v12 row_newbcast:12 row_mask:0xf bank_mask:0xf
    v_and_b32_dpp v53, v56, v13 row_newbcast:12 row_mask:0xf bank_mask:0xf
    v_and_b32_dpp v54, v56, v14 row_newbcast:12 row_mask:0xf bank_mask:0xf
    v_and_b32_dpp v55, v56, v15 row_newbcast:12 row_mask:0xf bank_mask:0xf
    v_mfma_f32_16x16x32_bf16 v[36:39], v[48:51], v[184:187], v[36:39]
    s_nop 0
    v_mfma_f32_16x16x32_bf16 v[36:39], v[52:55], v[188:191], v[36:39]
    s_waitcnt vmcnt(20)
    buffer_load_dwordx4 v[160:163], v3, s[8:11], s58 offen nt
    buffer_load_dwordx4 v[164:167], v3, s[8:11], s58 offen offset:1024 nt
    buffer_load_dwordx4 v[168:171], v3, s[8:11], s58 offen offset:2048 nt
    buffer_load_dwordx4 v[172:175], v3, s[8:11], s58 offen offset:3072 nt
    s_add_u32 s60, s60, 1
    s_ff1_i32_b32 s34, s60
    v_readlane_b32 s35, v59, s34
    buffer_load_dwordx4 v[176:179], v3, s[8:11], s59 offen nt
    buffer_load_dwordx4 v[180:183], v3, s[8:11], s59 offen offset:1024 nt
    buffer_load_dwordx4 v[184:187], v3, s[8:11], s59 offen offset:2048 nt
    buffer_load_dwordx4 v[188:191], v3, s[8:11], s59 offen offset:3072 nt
    s_xor_b32 s28, s28, s35
    s_mov_b32 s56, s28
    s_xor_b32 s57, s28, 0x10000
    s_xor_b32 s58, s28, 0x8000
    s_xor_b32 s59, s28, 0x18000
    s_barrier
    s_cmp_lg_u32 s29, 0
    s_cbranch_scc1 L_nohand_d
    ds_read_b64 v[10:11], v57
    v_xor_b32 v57, 8, v57
L_nohand_d:
    v_mfma_f32_16x16x32_bf16 v[16:19], v[64:67], v[20:23], 0
    v_mfma_f32_16x16x32_bf16 v[16:19], v[68:71], v[24:27], v[16:19]
    v_mfma_f32_16x16x32_bf16 v[16:19], v[72:75], v[28:31], v[16:19]
    v_mfma_f32_16x16x32_bf16 v[16:19], v[76:79], v[32:35], v[16:19]
    s_nop 7
    v_mov_b32_dpp v7, v16 quad_perm:[0,0,0,0] row_mask:0xf bank_mask:0xf
    v_mov_b32_dpp v9, v18 quad_perm:[2,2,2,2] row_mask:0xf bank_mask:0xf
    s_nop 0
    v_add_f32_dpp v7, v17, v7 quad_perm:[1,1,1,1] row_mask:0xf bank_mask:0xf
    v_add_f32_dpp v9, v19, v9 quad_perm:[3,3,3,3] row_mask:0xf bank_mask:0xf
    v_add_f32 v192, v7, v9
    s_waitcnt vmcnt(24)
    v_mfma_f32_16x16x32_bf16 v[16:19], v[80:83], v[20:23], 0
    v_mfma_f32_16x16x32_bf16 v[16:19], v[84:87], v[24:27], v[16:19]
    v_mfma_f32_16x16x32_bf16 v[16:19], v[88:91], v[28:31], v[16:19]
    v_mfma_f32_16x16x32_bf16 v[16:19], v[92:95], v[32:35], v[16:19]
    s_nop 7
    v_mov_b32_dpp v7, v16 quad_perm:[0,0,0,0] row_mask:0xf bank_mask:0xf
    v_mov_b32_dpp v9, v18 quad_perm:[2,2,2,2] row_mask:0xf bank_mask:0xf
    s_nop 0
    v_add_f32_dpp v7, v17, v7 quad_perm:[1,1,1,1] row_mask:0xf bank_mask:0xf
    v_add_f32_dpp v9, v19, v9 quad_perm:[3,3,3,3] row_mask:0xf bank_mask:0xf
    v_add_f32 v193, v7, v9
    s_cmp_eq_u32 s29, 0
    s_cbranch_scc1 L_dyn
    s_sub_u32 s29, s29, 1
    s_branch L_body_d
L_body_l:
    s_waitcnt vmcnt(24)
    buffer_load_dwordx4 v[64:67], v2, s[4:7], s56 offen nt
    buffer_load_dwordx4 v[68:71], v2, s[4:7], s56 offen offset:1024 nt
    buffer_load_dwordx4 v[72:75], v2, s[4:7], s56 offen offset:2048 nt
    buffer_load_dwordx4 v[76:79], v2, s[4:7], s56 offen offset:3072 nt
    buffer_load_dwordx4 v[80:83], v2, s[4:7], s57 offen nt
    buffer_load_dwordx4 v[84:87], v2, s[4:7], s57 offen offset:1024 nt
    buffer_load_dwordx4 v[88:91], v2, s[4:7], s57 offen offset:2048 nt
    buffer_load_dwordx4 v[92:95], v2, s[4:7], s57 offen offset:3072 nt
    s_waitcnt vmcnt(28)
    v_mfma_f32_16x16x32_bf16 v[16:19], v[96:99], v[20:23], 0
    v_mfma_f32_16x16x32_bf16 v[16:19], v[100:103], v[24:27], v[16:19]
    v_mfma_f32_16x16x32_bf16 v[16:19], v[104:107], v[28:31], v[16:19]
    v_mfma_f32_16x16x32_bf16 v[16:19], v[108:111], v[32:35], v[16:19]
    s_nop 7
    v_mov_b32_dpp v7, v16 quad_perm:[0,0,0,0] row_mask:0xf bank_mask:0xf
    v_mov_b32_dpp v9, v18 quad_perm:[2,2,2,2] row_mask:0xf bank_mask:0xf
    s_nop 0
    v_add_f32_dpp v7, v17, v7 quad_perm:[1,1,1,1] row_mask:0xf bank_mask:0xf
    v_add_f32_dpp v9, v19, v9 quad_perm:[3,3,3,3] row_mask:0xf bank_mask:0xf
    v_add_f32 v194, v7, v9
    s_waitcnt vmcnt(24)
    v_mfma_f32_16x16x32_bf16 v[16:19], v[112:115], v[20:23], 0
    v_mfma_f32_16x16x32_bf16 v[16:19], v[116:119], v[24:27], v[16:19]
    v_mfma_f32_16x16x32_bf16 v[16:19], v[120:123], v[28:31], v[16:19]
    v_mfma_f32_16x16x32_bf16 v[16:19], v[124:127], v[32:35], v[16:19]
    v_max3_f32 v8, v192, v193, v194
    s_nop 6
    v_mov_b32_dpp v7, v16 quad_perm:[0,0,0,0] row_mask:0xf bank_mask:0xf
    v_mov_b32_dpp v9, v18 quad_perm:[2,2,2,2] row_mask:0xf bank_mask:0xf
    s_nop 0
    v_add_f32_dpp v7, v17, v7 quad_perm:[1,1,1,1] row_mask:0xf bank_mask:0xf
    v_add_f32_dpp v9, v19, v9 quad_perm:[3,3,3,3] row_mask:0xf bank_mask:0xf
    v_add_f32 v195, v7, v9
    v_max_f32 v7, v8, v195
    v_cmp_gt_f32 vcc, v7, v4
    s_cbranch_vccnz L_rare_l1
L_back_l1:
    v_fma_f32 v8, v192, s30, -v5
    v_exp_f32 v8, v8
    s_nop 0
    v_cvt_pk_bf16_f32 v56, v8, v8
    v_add_f32 v6, v6, v8
    s_nop 0
    v_and_b32_dpp v40, v56, v12 row_newbcast:0 row_mask:0xf bank_mask:0xf
    v_and_b32_dpp v41, v56, v13 row_newbcast:0 row_mask:0xf bank_mask:0xf
    v_and_b32_dpp v42, v56, v14 row_newbcast:0 row_mask:0xf bank_mask:0xf
    v_and_b32_dpp v43, v56, v15 row_newbcast:0 row_mask:0xf bank_mask:0xf
    v_and_b32_dpp v44, v56, v12 row_newbcast:4 row_mask:0xf bank_mask:0xf
    v_and_b32_dpp v45, v56, v13 row_newbcast:4 row_mask:0xf bank_mask:0xf
    v_and_b32_dpp v46, v56, v14 row_newbcast:4 row_mask:0xf bank_mask:0xf
    v_and_b32_dpp v47, v56, v15 row_newbcast:4 row_mask:0xf bank_mask:0xf
    s_waitcnt vmcnt(24)
    buffer_load_dwordx4 v[96:99], v2, s[4:7], s58 offen nt
    buffer_load_dwordx4 v[100:103], v2, s[4:7], s58 offen offset:1024 nt
    buffer_load_dwordx4 v[104:107], v2, s[4:7], s58 offen offset:2048 nt
    buffer_load_dwordx4 v[108:111], v2, s[4:7], s58 offen offset:3072 nt
    buffer_load_dwordx4 v[112:115], v2, s[4:7], s59 offen nt
    buffer_load_dwordx4 v[116:119], v2, s[4:7], s59 offen offset:1024 nt
    buffer_load_dwordx4 v[120:123], v2, s[4:7], s59 offen offset:2048 nt
    buffer_load_dwordx4 v[124:127], v2, s[4:7], s59 offen offset:3072 nt
    s_waitcnt vmcnt(28)
    v_mfma_f32_16x16x32_bf16 v[36:39], v[40:43], v[128:131], v[36:39]
    v_and_b32_dpp v48, v56, v12 row_newbcast:8 row_mask:0xf bank_mask:0xf
    v_and_b32_dpp v49, v56, v13 row_newbcast:8 row_mask:0xf bank_mask:0xf
    v_and_b32_dpp v50, v56, v14 row_newbcast:8 row_mask:0xf bank_mask:0xf
    v_and_b32_dpp v51, v56, v15 row_newbcast:8 row_mask:0xf bank_mask:0xf
    v_mfma_f32_16x16x32_bf16 v[36:39], v[44:47], v[132:135], v[36:39]
    v_and_b32_dpp v52, v56, v12 row_newbcast:12 row_mask:0xf bank_mask:0xf
    v_and_b32_dpp v53, v56, v13 row_newbcast:12 row_mask:0xf bank_mask:0xf
    v_and_b32_dpp v54, v56, v14 row_newbcast:12 row_mask:0xf bank_mask:0xf
    v_and_b32_dpp v55, v56, v15 row_newbcast:12 row_mask:0xf bank_mask:0xf
    v_mfma_f32_16x16x32_bf16 v[36:39], v[48:51], v[136:139], v[36:39]
    s_nop 0
    v_mfma_f32_16x16x32_bf16 v[36:39], v[52:55], v[140:143], v[36:39]
    v_fma_f32 v8, v193, s30, -v5
    v_exp_f32 v8, v8
    s_nop 0
    v_cvt_pk_bf16_f32 v56, v8, v8
    v_add_f32 v6, v6, v8
    s_nop 0
    v_and_b32_dpp v40, v56, v12 row_newbcast:0 row_mask:0xf bank_mask:0xf
    v_and_b32_dpp v41, v56, v13 row_newbcast:0 row_mask:0xf bank_mask:0xf
    v_and_b32_dpp v42, v56, v14 row_newbcast:0 row_mask:0xf bank_mask:0xf
    v_and_b32_dpp v43, v56, v15 row_newbcast:0 row_mask:0xf bank_mask:0xf
    v_and_b32_dpp v44, v56, v12 row_newbcast:4 row_mask:0xf bank_mask:0xf
    v_and_b32_dpp v45, v56, v13 row_newbcast:4 row_mask:0xf bank_mask:0xf
    v_and_b32_dpp v46, v56, v14 row_newbcast:4 row_mask:0xf bank_mask:0xf
    v_and_b32_dpp v47, v56, v15 row_newbcast:4 row_mask:0xf bank_mask:0xf
    s_waitcnt vmcnt(24)
    v_mfma_f32_16x16x32_bf16 v[36:39], v[40:43], v[144:147], v[36:39]
    v_and_b32_dpp v48, v56, v12 row_newbcast:8 row_mask:0xf bank_mask:0xf
    v_and_b32_dpp v49, v56, v13 row_newbcast:8 row_mask:0xf bank_mask:0xf
    v_and_b32_dpp v50, v56, v14 row_newbcast:8 row_mask:0xf bank_mask:0xf
    v_and_b32_dpp v51, v56, v15 row_newbcast:8 row_mask:0xf bank_mask:0xf
    v_mfma_f32_16x16x32_bf16 v[36:39], v[44:47], v[148:151], v[36:39]
    v_and_b32_dpp v52, v56, v12 row_newbcast:12 row_mask:0xf bank_mask:0xf
    v_and_b32_dpp v53, v56, v13 row_newbcast:12 row_mask:0xf bank_mask:0xf
    v_and_b32_dpp v54, v56, v14 row_newbcast:12 row_mask:0xf bank_mask:0xf
    v_and_b32_dpp v55, v56, v15 row_newbcast:12 row_mask:0xf bank_mask:0xf
    v_mfma_f32_16x16x32_bf16 v[36:39], v[48:51], v[152:155], v[36:39]
    s_nop 0
    v_mfma_f32_16x16x32_bf16 v[36:39], v[52:55], v[156:159], v[36:39]
    v_fma_f32 v8, v194, s30, -v5
    v_exp_f32 v8, v8
    s_nop 0
    v_cvt_pk_bf16_f32 v56, v8, v8
    v_add_f32 v6, v6, v8
    s_nop 0
    v_and_b32_dpp v40, v56, v12 row_newbcast:0 row_mask:0xf bank_mask:0xf
    v_and_b32_dpp v41, v56, v13 row_newbcast:0 row_mask:0xf bank_mask:0xf
    v_and_b32_dpp v42, v56, v14 row_newbcast:0 row_mask:0xf bank_mask:0xf
    v_and_b32_dpp v43, v56, v15 row_newbcast:0 row_mask:0xf bank_mask:0xf
    v_and_b32_dpp v44, v56, v12 row_newbcast:4 row_mask:0xf bank_mask:0xf
    v_and_b32_dpp v45, v56, v13 row_newbcast:4 row_mask:0xf bank_mask:0xf
    v_and_b32_dpp v46, v56, v14 row_newbcast:4 row_mask:0xf bank_mask:0xf
    v_and_b32_dpp v47, v56, v15 row_newbcast:4 row_mask:0xf bank_mask:0xf
    s_waitcnt vmcnt(24)
    buffer_load_dwordx4 v[128:131], v3, s[8:11], s56 offen nt
    buffer_load_dwordx4 v[132:135], v3, s[8:11], s56 offen offset:1024 nt
    buffer_load_dwordx4 v[136:139], v3, s[8:11], s56 offen offset:2048 nt
    buffer_load_dwordx4 v[140:143], v3, s[8:11], s56 offen offset:3072 nt
    buffer_load_dwordx4 v[144:147], v3, s[8:11], s57 offen nt
    buffer_load_dwordx4 v[148:151], v3, s[8:11], s57 offen offset:1024 nt
    buffer_load_dwordx4 v[152:155], v3, s[8:11], s57 offen offset:2048 nt
    buffer_load_dwordx4 v[156:159], v3, s[8:11], s57 offen offset:3072 nt
    s_waitcnt vmcnt(28)
    v_mfma_f32_16x16x32_bf16 v[36:39], v[40:43], v[160:163], v[36:39]
    v_and_b32_dpp v48, v56, v12 row_newbcast:8 row_mask:0xf bank_mask:0xf
    v_and_b32_dpp v49, v56, v13 row_newbcast:8 row_mask:0xf bank_mask:0xf
    v_and_b32_dpp v50, v56, v14 row_newbcast:8 row_mask:0xf bank_mask:0xf
    v_and_b32_dpp v51, v56, v15 row_newbcast:8 row_mask:0xf bank_mask:0xf
    v_mfma_f32_16x16x32_bf16 v[36:39], v[44:47], v[164:167], v[36:39]
    v_and_b32_dpp v52, v56, v12 row_newbcast:12 row_mask:0xf bank_mask:0xf
    v_and_b32_dpp v53, v56, v13 row_newbcast:12 row_mask:0xf bank_mask:0xf
    v_and_b32_dpp v54, v56, v14 row_newbcast:12 row_mask:0xf bank_mask:0xf
    v_and_b32_dpp v55, v56, v15 row_newbcast:12 row_mask:0xf bank_mask:0xf
    v_mfma_f32_16x16x32_bf16 v[36:39], v[48:51], v[168:171], v[36:39]
    s_nop 0
    v_mfma_f32_16x16x32_bf16 v[36:39], v[52:55], v[172:175], v[36:39]
    v_fma_f32 v8, v195, s30, -v5
    v_exp_f32 v8, v8
    s_nop 0
    v_cvt_pk_bf16_f32 v56, v8, v8
    v_add_f32 v6, v6, v8
    s_nop 0
    v_and_b32_dpp v40, v56, v12 row_newbcast:0 row_mask:0xf bank_mask:0xf
    v_and_b32_dpp v41, v56, v13 row_newbcast:0 row_mask:0xf bank_mask:0xf
    v_and_b32_dpp v42, v56, v14 row_newbcast:0 row_mask:0xf bank_mask:0xf
    v_and_b32_dpp v43, v56, v15 row_newbcast:0 row_mask:0xf bank_mask:0xf
    v_and_b32_dpp v44, v56, v12 row_newbcast:4 row_mask:0xf bank_mask:0xf
    v_and_b32_dpp v45, v56, v13 row_newbcast:4 row_mask:0xf bank_mask:0xf
    v_and_b32_dpp v46, v56, v14 row_newbcast:4 row_mask:0xf bank_mask:0xf
    v_and_b32_dpp v47, v56, v15 row_newbcast:4 row_mask:0xf bank_mask:0xf
    s_waitcnt vmcnt(24)
    v_mfma_f32_16x16x32_bf16 v[36:39], v[40:43], v[176:179], v[36:39]
    v_and_b32_dpp v48, v56, v12 row_newbcast:8 row_mask:0xf bank_mask:0xf
    v_and_b32_dpp v49, v56, v13 row_newbcast:8 row_mask:0xf bank_mask:0xf
    v_and_b32_dpp v50, v56, v14 row_newbcast:8 row_mask:0xf bank_mask:0xf
    v_and_b32_dpp v51, v56, v15 row_newbcast:8 row_mask:0xf bank_mask:0xf
    v_mfma_f32_16x16x32_bf16 v[36:39], v[44:47], v[180:183], v[36:39]
    v_and_b32_dpp v52, v56, v12 row_newbcast:12 row_mask:0xf bank_mask:0xf
    v_and_b32_dpp v53, v56, v13 row_newbcast:12 row_mask:0xf bank_mask:0xf
    v_and_b32_dpp v54, v56, v14 row_newbcast:12 row_mask:0xf bank_mask:0xf
    v_and_b32_dpp v55, v56, v15 row_newbcast:12 row_mask:0xf bank_mask:0xf
    v_mfma_f32_16x16x32_bf16 v[36:39], v[48:51], v[184:187], v[36:39]
    s_nop 0
    v_mfma_f32_16x16x32_bf16 v[36:39], v[52:55], v[188:191], v[36:39]
    s_waitcnt vmcnt(24)
    buffer_load_dwordx4 v[160:163], v3, s[8:11], s58 offen nt
    buffer_load_dwordx4 v[164:167], v3, s[8:11], s58 offen offset:1024 nt
    buffer_load_dwordx4 v[168:171], v3, s[8:11], s58 offen offset:2048 nt
    buffer_load_dwordx4 v[172:175], v3, s[8:11], s58 offen offset:3072 nt
    s_add_u32 s60, s60, 1
    s_ff1_i32_b32 s34, s60
    v_readlane_b32 s35, v59, s34
    buffer_load_dwordx4 v[176:179], v3, s[8:11], s59 offen nt
    buffer_load_dwordx4 v[180:183], v3, s[8:11], s59 offen offset:1024 nt
    buffer_load_dwordx4 v[184:187], v3, s[8:11], s59 offen offset:2048 nt
    buffer_load_dwordx4 v[188:191], v3, s[8:11], s59 offen offset:3072 nt
    s_xor_b32 s28, s28, s35
    s_mov_b32 s56, s28
    s_xor_b32 s57, s28, 0x10000
    s_xor_b32 s58, s28, 0x8000
    s_xor_b32 s59, s28, 0x18000
    s_barrier
    s_cmp_lg_u32 s29, 0
    s_cbranch_scc1 L_nohand_l
    ds_read_b64 v[10:11], v57
    v_xor_b32 v57, 8, v57
L_nohand_l:
    s_waitcnt vmcnt(28)
    v_mfma_f32_16x16x32_bf16 v[16:19], v[64:67], v[20:23], 0
    v_mfma_f32_16x16x32_bf16 v[16:19], v[68:71], v[24:27], v[16:19]
    v_mfma_f32_16x16x32_bf16 v[16:19], v[72:75], v[28:31], v[16:19]
    v_mfma_f32_16x16x32_bf16 v[16:19], v[76:79], v[32:35], v[16:19]
    s_nop 7
    v_mov_b32_dpp v7, v16 quad_perm:[0,0,0,0] row_mask:0xf bank_mask:0xf
    v_mov_b32_dpp v9, v18 quad_perm:[2,2,2,2] row_mask:0xf bank_mask:0xf
    s_nop 0
    v_add_f32_dpp v7, v17, v7 quad_perm:[1,1,1,1] row_mask:0xf bank_mask:0xf
    v_add_f32_dpp v9, v19, v9 quad_perm:[3,3,3,3] row_mask:0xf bank_mask:0xf
    v_add_f32 v192, v7, v9
    s_waitcnt vmcnt(24)
    v_mfma_f32_16x16x32_bf16 v[16:19], v[80:83], v[20:23], 0
    v_mfma_f32_16x16x32_bf16 v[16:19], v[84:87], v[24:27], v[16:19]
    v_mfma_f32_16x16x32_bf16 v[16:19], v[88:91], v[28:31], v[16:19]
    v_mfma_f32_16x16x32_bf16 v[16:19], v[92:95], v[32:35], v[16:19]
    s_nop 7
    v_mov_b32_dpp v7, v16 quad_perm:[0,0,0,0] row_mask:0xf bank_mask:0xf
    v_mov_b32_dpp v9, v18 quad_perm:[2,2,2,2] row_mask:0xf bank_mask:0xf
    s_nop 0
    v_add_f32_dpp v7, v17, v7 quad_perm:[1,1,1,1] row_mask:0xf bank_mask:0xf
    v_add_f32_dpp v9, v19, v9 quad_perm:[3,3,3,3] row_mask:0xf bank_mask:0xf
    v_add_f32 v193, v7, v9
    s_cmp_eq_u32 s29, 0
    s_cbranch_scc1 L_dyn
    s_sub_u32 s29, s29, 1
    s_branch L_body_l
L_drain:
    ds_read_b128 v[60:63], v3
    s_waitcnt vmcnt(20)
    v_mfma_f32_16x16x32_bf16 v[16:19], v[96:99], v[20:23], 0
    v_mfma_f32_16x16x32_bf16 v[16:19], v[100:103], v[24:27], v[16:19]
    v_mfma_f32_16x16x32_bf16 v[16:19], v[104:107], v[28:31], v[16:19]
    v_mfma_f32_16x16x32_bf16 v[16:19], v[108:111], v[32:35], v[16:19]
    s_nop 7
    v_mov_b32_dpp v7, v16 quad_perm:[0,0,0,0] row_mask:0xf bank_mask:0xf
    v_mov_b32_dpp v9, v18 quad_perm:[2,2,2,2] row_mask:0xf bank_mask:0xf
    s_nop 0
    v_add_f32_dpp v7, v17, v7 quad_perm:[1,1,1,1] row_mask:0xf bank_mask:0xf
    v_add_f32_dpp v9, v19, v9 quad_perm:[3,3,3,3] row_mask:0xf bank_mask:0xf
    v_add_f32 v194, v7, v9
    s_waitcnt vmcnt(16)
    v_mfma_f32_16x16x32_bf16 v[16:19], v[112:115], v[20:23], 0
    v_mfma_f32_16x16x32_bf16 v[16:19], v[116:119], v[24:27], v[16:19]
    v_mfma_f32_16x16x32_bf16 v[16:19], v[120:123], v[28:31], v[16:19]
    v_mfma_f32_16x16x32_bf16 v[16:19], v[124:127], v[32:35], v[16:19]
    v_max3_f32 v8, v192, v193, v194
    s_nop 6
    v_mov_b32_dpp v7, v16 quad_perm:[0,0,0,0] row_mask:0xf bank_mask:0xf
    v_mov_b32_dpp v9, v18 quad_perm:[2,2,2,2] row_mask:0xf bank_mask:0xf
    s_nop 0
    v_add_f32_dpp v7, v17, v7 quad_perm:[1,1,1,1] row_mask:0xf bank_mask:0xf
    v_add_f32_dpp v9, v19, v9 quad_perm:[3,3,3,3] row_mask:0xf bank_mask:0xf
    v_add_f32 v195, v7, v9
    v_max_f32 v7, v8, v195
    v_cmp_gt_f32 vcc, v7, v4
    s_cbranch_vccnz L_rare_t1
L_back_t1:
    v_fma_f32 v8, v192, s30, -v5
    v_exp_f32 v8, v8
    s_nop 0
    v_cvt_pk_bf16_f32 v56, v8, v8
    v_add_f32 v6, v6, v8
    s_nop 0
    v_and_b32_dpp v40, v56, v12 row_newbcast:0 row_mask:0xf bank_mask:0xf
    v_and_b32_dpp v41, v56, v13 row_newbcast:0 row_mask:0xf bank_mask:0xf
    v_and_b32_dpp v42, v56, v14 row_newbcast:0 row_mask:0xf bank_mask:0xf
    v_and_b32_dpp v43, v56, v15 row_newbcast:0 row_mask:0xf bank_mask:0xf
    v_and_b32_dpp v44, v56, v12 row_newbcast:4 row_mask:0xf bank_mask:0xf
    v_and_b32_dpp v45, v56, v13 row_newbcast:4 row_mask:0xf bank_mask:0xf
    v_and_b32_dpp v46, v56, v14 row_newbcast:4 row_mask:0xf bank_mask:0xf
    v_and_b32_dpp v47, v56, v15 row_newbcast:4 row_mask:0xf bank_mask:0xf
    s_waitcnt vmcnt(12)
    v_mfma_f32_16x16x32_bf16 v[36:39], v[40:43], v[128:131], v[36:39]
    v_and_b32_dpp v48, v56, v12 row_newbcast:8 row_mask:0xf bank_mask:0xf
    v_and_b32_dpp v49, v56, v13 row_newbcast:8 row_mask:0xf bank_mask:0xf
    v_and_b32_dpp v50, v56, v14 row_newbcast:8 row_mask:0xf bank_mask:0xf
    v_and_b32_dpp v51, v56, v15 row_newbcast:8 row_mask:0xf bank_mask:0xf
    v_mfma_f32_16x16x32_bf16 v[36:39], v[44:47], v[132:135], v[36:39]
    v_and_b32_dpp v52, v56, v12 row_newbcast:12 row_mask:0xf bank_mask:0xf
    v_and_b32_dpp v53, v56, v13 row_newbcast:12 row_mask:0xf bank_mask:0xf
    v_and_b32_dpp v54, v56, v14 row_newbcast:12 row_mask:0xf bank_mask:0xf
    v_and_b32_dpp v55, v56, v15 row_newbcast:12 row_mask:0xf bank_mask:0xf
    v_mfma_f32_16x16x32_bf16 v[36:39], v[48:51], v[136:139], v[36:39]
    s_nop 0
    v_mfma_f32_16x16x32_bf16 v[36:39], v[52:55], v[140:143], v[36:39]
    v_fma_f32 v8, v193, s30, -v5
    v_exp_f32 v8, v8
    s_nop 0
    v_cvt_pk_bf16_f32 v56, v8, v8
    v_add_f32 v6, v6, v8
    s_nop 0
    v_and_b32_dpp v40, v56, v12 row_newbcast:0 row_mask:0xf bank_mask:0xf
    v_and_b32_dpp v41, v56, v13 row_newbcast:0 row_mask:0xf bank_mask:0xf
    v_and_b32_dpp v42, v56, v14 row_newbcast:0 row_mask:0xf bank_mask:0xf
    v_and_b32_dpp v43, v56, v15 row_newbcast:0 row_mask:0xf bank_mask:0xf
    v_and_b32_dpp v44, v56, v12 row_newbcast:4 row_mask:0xf bank_mask:0xf
    v_and_b32_dpp v45, v56, v13 row_newbcast:4 row_mask:0xf bank_mask:0xf
    v_and_b32_dpp v46, v56, v14 row_newbcast:4 row_mask:0xf bank_mask:0xf
    v_and_b32_dpp v47, v56, v15 row_newbcast:4 row_mask:0xf bank_mask:0xf
    s_waitcnt vmcnt(8)
    v_mfma_f32_16x16x32_bf16 v[36:39], v[40:43], v[144:147], v[36:39]
    v_and_b32_dpp v48, v56, v12 row_newbcast:8 row_mask:0xf bank_mask:0xf
    v_and_b32_dpp v49, v56, v13 row_newbcast:8 row_mask:0xf bank_mask:0xf
    v_and_b32_dpp v50, v56, v14 row_newbcast:8 row_mask:0xf bank_mask:0xf
    v_and_b32_dpp v51, v56, v15 row_newbcast:8 row_mask:0xf bank_mask:0xf
    v_mfma_f32_16x16x32_bf16 v[36:39], v[44:47], v[148:151], v[36:39]
    v_and_b32_dpp v52, v56, v12 row_newbcast:12 row_mask:0xf bank_mask:0xf
    v_and_b32_dpp v53, v56, v13 row_newbcast:12 row_mask:0xf bank_mask:0xf
    v_and_b32_dpp v54, v56, v14 row_newbcast:12 row_mask:0xf bank_mask:0xf
    v_and_b32_dpp v55, v56, v15 row_newbcast:12 row_mask:0xf bank_mask:0xf
    v_mfma_f32_16x16x32_bf16 v[36:39], v[48:51], v[152:155], v[36:39]
    s_nop 0
    v_mfma_f32_16x16x32_bf16 v[36:39], v[52:55], v[156:159], v[36:39]
    v_fma_f32 v8, v194, s30, -v5
    v_exp_f32 v8, v8
    s_nop 0
    v_cvt_pk_bf16_f32 v56, v8, v8
    v_add_f32 v6, v6, v8
    s_nop 0
    v_and_b32_dpp v40, v56, v12 row_newbcast:0 row_mask:0xf bank_mask:0xf
    v_and_b32_dpp v41, v56, v13 row_newbcast:0 row_mask:0xf bank_mask:0xf
    v_and_b32_dpp v42, v56, v14 row_newbcast:0 row_mask:0xf bank_mask:0xf
    v_and_b32_dpp v43, v56, v15 row_newbcast:0 row_mask:0xf bank_mask:0xf
    v_and_b32_dpp v44, v56, v12 row_newbcast:4 row_mask:0xf bank_mask:0xf
    v_and_b32_dpp v45, v56, v13 row_newbcast:4 row_mask:0xf bank_mask:0xf
    v_and_b32_dpp v46, v56, v14 row_newbcast:4 row_mask:0xf bank_mask:0xf
    v_and_b32_dpp v47, v56, v15 row_newbcast:4 row_mask:0xf bank_mask:0xf
    s_waitcnt vmcnt(4)
    s_barrier
    v_mfma_f32_16x16x32_bf16 v[36:39], v[40:43], v[160:163], v[36:39]
    v_and_b32_dpp v48, v56, v12 row_newbcast:8 row_mask:0xf bank_mask:0xf
    v_and_b32_dpp v49, v56, v13 row_newbcast:8 row_mask:0xf bank_mask:0xf
    v_and_b32_dpp v50, v56, v14 row_newbcast:8 row_mask:0xf bank_mask:0xf
    v_and_b32_dpp v51, v56, v15 row_newbcast:8 row_mask:0xf bank_mask:0xf
    v_mfma_f32_16x16x32_bf16 v[36:39], v[44:47], v[164:167], v[36:39]
    v_and_b32_dpp v52, v56, v12 row_newbcast:12 row_mask:0xf bank_mask:0xf
    v_and_b32_dpp v53, v56, v13 row_newbcast:12 row_mask:0xf bank_mask:0xf
    v_and_b32_dpp v54, v56, v14 row_newbcast:12 row_mask:0xf bank_mask:0xf
    v_and_b32_dpp v55, v56, v15 row_newbcast:12 row_mask:0xf bank_mask:0xf
    v_mfma_f32_16x16x32_bf16 v[36:39], v[48:51], v[168:171], v[36:39]
    s_nop 0
    v_mfma_f32_16x16x32_bf16 v[36:39], v[52:55], v[172:175], v[36:39]
    v_fma_f32 v8, v195, s30, -v5
    v_exp_f32 v8, v8
    s_nop 0
    v_cvt_pk_bf16_f32 v56, v8, v8
    v_add_f32 v6, v6, v8
    s_nop 0
    v_and_b32_dpp v40, v56, v12 row_newbcast:0 row_mask:0xf bank_mask:0xf
    v_and_b32_dpp v41, v56, v13 row_newbcast:0 row_mask:0xf bank_mask:0xf
    v_and_b32_dpp v42, v56, v14 row_newbcast:0 row_mask:0xf bank_mask:0xf
    v_and_b32_dpp v43, v56, v15 row_newbcast:0 row_mask:0xf bank_mask:0xf
    v_and_b32_dpp v44, v56, v12 row_newbcast:4 row_mask:0xf bank_mask:0xf
    v_and_b32_dpp v45, v56, v13 row_newbcast:4 row_mask:0xf bank_mask:0xf
    v_and_b32_dpp v46, v56, v14 row_newbcast:4 row_mask:0xf bank_mask:0xf
    v_and_b32_dpp v47, v56, v15 row_newbcast:4 row_mask:0xf bank_mask:0xf
    v_and_b32_dpp v48, v56, v12 row_newbcast:8 row_mask:0xf bank_mask:0xf
    v_and_b32_dpp v49, v56, v13 row_newbcast:8 row_mask:0xf bank_mask:0xf
    v_and_b32_dpp v50, v56, v14 row_newbcast:8 row_mask:0xf bank_mask:0xf
    v_and_b32_dpp v51, v56, v15 row_newbcast:8 row_mask:0xf bank_mask:0xf
    v_and_b32_dpp v52, v56, v12 row_newbcast:12 row_mask:0xf bank_mask:0xf
    v_and_b32_dpp v53, v56, v13 row_newbcast:12 row_mask:0xf bank_mask:0xf
    v_and_b32_dpp v54, v56, v14 row_newbcast:12 row_mask:0xf bank_mask:0xf
    v_and_b32_dpp v55, v56, v15 row_newbcast:12 row_mask:0xf bank_mask:0xf
    v_add_f32_dpp v6, v6, v6 row_ror:4 row_mask:0xf bank_mask:0xf
    s_nop 1
    v_add_f32_dpp v6, v6, v6 row_ror:8 row_mask:0xf bank_mask:0xf
    v_mov_b32 v7, v6
    s_nop 1
    v_permlane32_swap_b32 v6, v7
    s_nop 1
    v_add_f32 v6, v6, v7
    v_mov_b32 v7, v6
    s_nop 1
    v_permlane16_swap_b32 v6, v7
    s_nop 1
    v_add_f32 v6, v6, v7
    s_waitcnt lgkmcnt(0)
    s_waitcnt vmcnt(0)
    s_nop 0
    v_mfma_f32_16x16x32_bf16 v[36:39], v[40:43], v[176:179], v[36:39]
    v_mfma_f32_16x16x32_bf16 v[36:39], v[44:47], v[180:183], v[36:39]
    v_mfma_f32_16x16x32_bf16 v[36:39], v[48:51], v[184:187], v[36:39]
    v_mfma_f32_16x16x32_bf16 v[36:39], v[52:55], v[188:191], v[36:39]
    s_nop 7
    v_mov_b32_dpp v36, v4 quad_perm:[0,1,2,3] row_mask:0x4 bank_mask:0xf
    v_mov_b32_dpp v37, v6 quad_perm:[0,1,2,3] row_mask:0x4 bank_mask:0xf
    v_bfi_b32 v38, 1, v62, v38
    v_bfi_b32 v39, 1, v63, v39
    v_bfi_b32 v36, 1, v60, v36
    v_bfi_b32 v37, 1, v61, v37
    buffer_store_dwordx4 v[36:39], v58, s[12:15], 0 offen sc1
L_end:
    s_endpgm
L_main:
    s_waitcnt lgkmcnt(0)
    v_readfirstlane_b32 s28, v10
    v_readfirstlane_b32 s3, v11
    s_mov_b32 s61, 1
    s_mov_b32 s60, 4
    s_mov_b32 s29, 0x6a
    s_mov_b32 s56, s28
    s_xor_b32 s57, s28, 0x10000
    s_xor_b32 s58, s28, 0x8000
    s_xor_b32 s59, s28, 0x18000
    s_branch L_loop
L_hook:
    s_lshl_b32 s34, s61, 1
    s_add_u32 s34, s34, 1
    s_cmp_gt_u32 s29, s34
    s_cbranch_scc1 L_hook_back
    s_barrier
    s_cmp_ge_u32 s29, 2
    s_cbranch_scc1 L_hook_back
    ds_read_b64 v[10:11], v57
    v_xor_b32 v57, 8, v57
    s_branch L_hook_back
L_rare_m1:
    v_mov_b32 v8, v7
    s_nop 1
    v_max_f32_dpp v8, v8, v8 row_ror:4 row_mask:0xf bank_mask:0xf
    s_nop 1
    v_max_f32_dpp v8, v8, v8 row_ror:8 row_mask:0xf bank_mask:0xf
    s_nop 1
    v_readlane_b32 s40, v8, 0
    v_readlane_b32 s41, v8, 16
    v_readlane_b32 s42, v8, 32
    v_readlane_b32 s43, v8, 48
    s_nop 1
    v_max_f32 v8, s40, v4
    v_max_f32 v8, s41, v8
    v_max_f32 v8, s42, v8
    v_max_f32 v8, s43, v8
    v_sub_f32 v9, v4, v8
    v_mul_f32 v9, s30, v9
    v_exp_f32 v9, v9
    v_mov_b32 v4, v8
    v_mul_f32 v5, s30, v8
    v_mul_f32 v6, v6, v9
    v_mul_f32 v36, v36, v9
    v_mul_f32 v37, v37, v9
    v_mul_f32 v38, v38, v9
    v_mul_f32 v39, v39, v9
    s_branch L_back_m1
L_rare_d1:
    v_mov_b32 v8, v7
    s_nop 1
    v_max_f32_dpp v8, v8, v8 row_ror:4 row_mask:0xf bank_mask:0xf
    s_nop 1
    v_max_f32_dpp v8, v8, v8 row_ror:8 row_mask:0xf bank_mask:0xf
    s_nop 1
    v_readlane_b32 s40, v8, 0
    v_readlane_b32 s41, v8, 16
    v_readlane_b32 s42, v8, 32
    v_readlane_b32 s43, v8, 48
    s_nop 1
    v_max_f32 v8, s40, v4
    v_max_f32 v8, s41, v8
    v_max_f32 v8, s42, v8
    v_max_f32 v8, s43, v8
    v_sub_f32 v9, v4, v8
    v_mul_f32 v9, s30, v9
    v_exp_f32 v9, v9
    v_mov_b32 v4, v8
    v_mul_f32 v5, s30, v8
    v_mul_f32 v6, v6, v9
    v_mul_f32 v36, v36, v9
    v_mul_f32 v37, v37, v9
    v_mul_f32 v38, v38, v9
    v_mul_f32 v39, v39, v9
    s_branch L_back_d1
L_rare_l1:
    v_mov_b32 v8, v7
    s_nop 1
    v_max_f32_dpp v8, v8, v8 row_ror:4 row_mask:0xf bank_mask:0xf
    s_nop 1
    v_max_f32_dpp v8, v8, v8 row_ror:8 row_mask:0xf bank_mask:0xf
    s_nop 1
    v_readlane_b32 s40, v8, 0
    v_readlane_b32 s41, v8, 16
    v_readlane_b32 s42, v8, 32
    v_readlane_b32 s43, v8, 48
    s_nop 1
    v_max_f32 v8, s40, v4
    v_max_f32 v8, s41, v8
    v_max_f32 v8, s42, v8
    v_max_f32 v8, s43, v8
    v_sub_f32 v9, v4, v8
    v_mul_f32 v9, s30, v9
    v_exp_f32 v9, v9
    v_mov_b32 v4, v8
    v_mul_f32 v5, s30, v8
    v_mul_f32 v6, v6, v9
    v_mul_f32 v36, v36, v9
    v_mul_f32 v37, v37, v9
    v_mul_f32 v38, v38, v9
    v_mul_f32 v39, v39, v9
    s_branch L_back_l1
L_rare_t1:
    v_mov_b32 v8, v7
    s_nop 1
    v_max_f32_dpp v8, v8, v8 row_ror:4 row_mask:0xf bank_mask:0xf
    s_nop 1
    v_max_f32_dpp v8, v8, v8 row_ror:8 row_mask:0xf bank_mask:0xf
    s_nop 1
    v_readlane_b32 s40, v8, 0
    v_readlane_b32 s41, v8, 16
    v_readlane_b32 s42, v8, 32
    v_readlane_b32 s43, v8, 48
    s_nop 1
    v_max_f32 v8, s40, v4
    v_max_f32 v8, s41, v8
    v_max_f32 v8, s42, v8
    v_max_f32 v8, s43, v8
    v_sub_f32 v9, v4, v8
    v_mul_f32 v9, s30, v9
    v_exp_f32 v9, v9
    v_mov_b32 v4, v8
    v_mul_f32 v5, s30, v8
    v_mul_f32 v6, v6, v9
    v_mul_f32 v36, v36, v9
    v_mul_f32 v37, v37, v9
    v_mul_f32 v38, v38, v9
    v_mul_f32 v39, v39, v9
    s_branch L_back_t1
L_helper:
    s_lshl_b32 s38, s31, 3
    s_mov_b32 s39, 0x1400
    s_mov_b32 s33, 0
    v_lshlrev_b32 v57, 20, v0
    v_mov_b32 v56, 1024
    s_mov_b32 s18, 0x100
    s_mov_b32 s19, 0x00020000
    s_mov_b32 s22, 0x100
    s_mov_b32 s23, 0x00020000
    s_lshl_b32 s34, s32, 9
    s_lshl_b32 s37, s32, 7
    s_add_u32 s37, s37, 4096
    v_add_u32 v58, s34, v3
    v_subrev_u32 v7, 32, v0
    v_lshlrev_b32 v7, 16, v7
    v_add_u32 v7, s37, v7
    v_cmp_gt_u32 vcc, 32, v0
    s_nop 1
    v_cndmask_b32 v58, v7, v58, vcc
    v_lshrrev_b32 v7, 5, v0
    v_xor_b32 v7, v7, v0
    v_and_b32 v7, 7, v7
    v_lshlrev_b32 v7, 7, v7
    v_add_u32 v2, 4096, v7
    s_waitcnt lgkmcnt(0)
    s_add_u32 s12, s54, s36
    s_addc_u32 s13, s55, 0
    s_add_u32 s16, s50, s35
    s_addc_u32 s17, s51, 0
    s_mov_b32 s20, s52
    s_mov_b32 s21, s53
    buffer_load_dwordx4 v[60:63], v58, s[12:15], 0 offen sc1
    s_cmp_lg_u32 s32, 0
    s_cbranch_scc1 L_flag0
    buffer_load_dwordx4 v[64:67], v3, s[12:15], 0 offen sc1
    buffer_load_dwordx4 v[68:71], v3, s[12:15], 0 offen offset:1024 sc1
    buffer_load_dwordx4 v[72:75], v3, s[12:15], 0 offen offset:2048 sc1
    buffer_load_dwordx4 v[76:79], v3, s[12:15], 0 offen offset:3072 sc1
    buffer_load_dwordx2 v[80:81], v2, s[12:15], 0 offen sc1
    v_mov_b32 v7, 0
    v_mov_b32 v1, 1
    buffer_store_dword v7, v57, s[12:15], s39 offen sc1
    s_waitcnt vmcnt(0)
    buffer_store_dword v1, v57, s[20:23], s38 offen sc1
L_flag0:
    s_getreg_b32 s40, hwreg(HW_REG_XCC_ID)
    s_and_b32 s40, s40, 7
L_claim:
    s_lshl_b32 s35, 1, s40
    v_mov_b32 v7, s35
    buffer_atomic_or v7, v57, s[20:23], s38 offen offset:4 sc0 sc1
    s_waitcnt vmcnt(0)
    v_readfirstlane_b32 s34, v7
    s_and_b32 s35, s35, s34
    s_cbranch_scc0 L_claimed
    s_ff0_i32_b32 s40, s34
    s_cmp_lt_u32 s40, 8
    s_cbranch_scc1 L_claim
    s_mov_b32 s40, s32
L_claimed:
    s_mov_b32 s28, 0x40000
    s_bitcmp1_b32 s40, 0
    s_cselect_b32 s37, 0x145000, 0
    s_xor_b32 s28, s28, s37
    s_bitcmp1_b32 s40, 1
    s_cselect_b32 s37, 0x46000, 0
    s_xor_b32 s28, s28, s37
    s_bitcmp1_b32 s40, 2
    s_cselect_b32 s37, 0x101000, 0
    s_xor_b32 s28, s28, s37
    s_bitcmp1_b32 s31, 0
    s_cselect_b32 s37, 0x580000, 0
    s_xor_b32 s28, s28, s37
    s_bitcmp1_b32 s31, 1
    s_cselect_b32 s37, 0x402000, 0
    s_xor_b32 s28, s28, s37
    s_bitcmp1_b32 s31, 2
    s_cselect_b32 s37, 0x101000, 0
    s_xor_b32 s28, s28, s37
    s_bitcmp1_b32 s31, 3
    s_cselect_b32 s37, 0x763000, 0
    s_xor_b32 s28, s28, s37
    s_bitcmp1_b32 s31, 4
    s_cselect_b32 s37, 0x8000, 0
    s_xor_b32 s28, s28, s37
    v_mov_b32 v10, s28
    v_mov_b32 v11, 0
    ds_write_b64 v56, v[10:11]
    v_xor_b32 v56, 8, v56
    s_waitcnt lgkmcnt(0)
    s_barrier
    s_and_b32 s40, s40, 0x2
    s_bcnt1_i32_b32 s40, s40
    s_and_b32 s40, s40, 1
    s_lshl_b32 s41, s40, 4
    s_lshl_b32 s42, 1, s41
    s_barrier
L_flag:
    buffer_load_dword v1, v57, s[20:23], s38 offen sc1
    s_waitcnt vmcnt(0)
    s_add_u32 s33, s33, 0x200
    s_cbranch_scc1 L_ready
    v_readfirstlane_b32 s34, v1
    s_cmp_eq_u32 s34, 0
    s_cbranch_scc1 L_flag
L_ready:
    v_mov_b32 v20, 0
    v_mov_b32 v21, -1
    s_mov_b32 s34, 0x8cd000
    s_mov_b32 s35, 0x6e0e
    v_writelane_b32 v20, s34, 0
    v_writelane_b32 v21, s35, 0
    s_mov_b32 s34, 0x988000
    s_mov_b32 s35, 0x6e0e
    v_writelane_b32 v20, s34, 1
    v_writelane_b32 v21, s35, 1
    s_mov_b32 s34, 0x9cc000
    s_mov_b32 s35, 0x6e06
    v_writelane_b32 v20, s34, 2
    v_writelane_b32 v21, s35, 2
    s_mov_b32 s34, 0x889000
    s_mov_b32 s35, 0x6e06
    v_writelane_b32 v20, s34, 3
    v_writelane_b32 v21, s35, 3
    s_mov_b32 s34, 0x26b000
    s_mov_b32 s35, 0x7504
    v_writelane_b32 v20, s34, 4
    v_writelane_b32 v21, s35, 4
    s_mov_b32 s34, 0x32e000
    s_mov_b32 s35, 0x7504
    v_writelane_b32 v20, s34, 5
    v_writelane_b32 v21, s35, 5
    s_mov_b32 s34, 0xdac000
    s_mov_b32 s35, 0x7a02
    v_writelane_b32 v20, s34, 6
    v_writelane_b32 v21, s35, 6
    s_mov_b32 s34, 0xce9000
    s_mov_b32 s35, 0x7a02
    v_writelane_b32 v20, s34, 7
    v_writelane_b32 v21, s35, 7
    s_mov_b32 s34, 0xa6b000
    s_mov_b32 s35, 0x7d01
    v_writelane_b32 v20, s34, 8
    v_writelane_b32 v21, s35, 8
    s_mov_b32 s34, 0xb2e000
    s_mov_b32 s35, 0x7d01
    v_writelane_b32 v20, s34, 9
    v_writelane_b32 v21, s35, 9
    s_mov_b32 s34, 0xb6a000
    s_mov_b32 s35, 0x7d01
    v_writelane_b32 v20, s34, 10
    v_writelane_b32 v21, s35, 10
    s_mov_b32 s34, 0xb2c000
    s_mov_b32 s35, 0x7d01
    v_writelane_b32 v20, s34, 11
    v_writelane_b32 v21, s35, 11
    s_mov_b32 s34, 0xa2f000
    s_mov_b32 s35, 0x7d01
    v_writelane_b32 v20, s34, 12
    v_writelane_b32 v21, s35, 12
    s_mov_b32 s34, 0xa69000
    s_mov_b32 s35, 0x7d01
    v_writelane_b32 v20, s34, 13
    v_writelane_b32 v21, s35, 13
    s_mov_b32 s34, 0xeef000
    s_mov_b32 s35, 0x7f00
    v_writelane_b32 v20, s34, 14
    v_writelane_b32 v21, s35, 14
    s_mov_b32 s34, 0xea9000
    s_mov_b32 s35, 0x7f00
    v_writelane_b32 v20, s34, 15
    v_writelane_b32 v21, s35, 15
    s_mov_b32 s34, 0xfaa000
    s_mov_b32 s35, 0x7f00
    v_writelane_b32 v20, s34, 16
    v_writelane_b32 v21, s35, 16
    s_mov_b32 s34, 0xfec000
    s_mov_b32 s35, 0x7f00
    v_writelane_b32 v20, s34, 17
    v_writelane_b32 v21, s35, 17
    s_mov_b32 s34, 0xfee000
    s_mov_b32 s35, 0x7f80
    v_writelane_b32 v20, s34, 18
    v_writelane_b32 v21, s35, 18
    s_mov_b32 s34, 0xfa8000
    s_mov_b32 s35, 0x7f80
    v_writelane_b32 v20, s34, 19
    v_writelane_b32 v21, s35, 19
    s_mov_b32 s34, 0xeab000
    s_mov_b32 s35, 0x7f80
    v_writelane_b32 v20, s34, 20
    v_writelane_b32 v21, s35, 20
    s_mov_b32 s34, 0xeed000
    s_mov_b32 s35, 0x7f80
    v_writelane_b32 v20, s34, 21
    v_writelane_b32 v21, s35, 21
    s_mov_b32 s61, 0
    s_bitcmp1_b32 s31, 0
    s_cselect_b32 s37, 0x580000, 0
    s_xor_b32 s61, s61, s37
    s_bitcmp1_b32 s31, 1
    s_cselect_b32 s37, 0x446000, 0
    s_xor_b32 s61, s61, s37
    s_bitcmp1_b32 s31, 2
    s_cselect_b32 s37, 0x101000, 0
    s_xor_b32 s61, s61, s37
    s_bitcmp1_b32 s31, 3
    s_cselect_b32 s37, 0x662000, 0
    s_xor_b32 s61, s61, s37
    s_bitcmp1_b32 s31, 4
    s_cselect_b32 s37, 0x8000, 0
    s_xor_b32 s61, s61, s37
    s_mov_b32 s43, s61
    s_bitcmp1_b32 s40, 0
    s_cselect_b32 s37, 0x46000, 0
    s_xor_b32 s61, s61, s37
    v_not_b32 v60, v60
    v_not_b32 v61, v61
    v_not_b32 v62, v62
    v_not_b32 v63, v63
    ds_write_b128 v3, v[60:63]
    s_waitcnt vmcnt(0) lgkmcnt(0)
    s_barrier
L_tick:
    v_mov_b32 v1, s42
    buffer_atomic_add v1, v57, s[12:15], s39 offen sc0 sc1
    s_waitcnt vmcnt(0)
    v_readfirstlane_b32 s34, v1
    s_and_b32 s35, s34, 0xffff
    s_lshr_b32 s36, s34, 16
    s_lshr_b32 s34, s34, s41
    s_and_b32 s34, s34, 0xffff
    s_max_u32 s35, s35, 0xa
    s_max_u32 s36, s36, 0xa
    s_add_u32 s35, s35, s36
    s_sub_u32 s35, s35, 0xa
    s_cmp_ge_u32 s34, 0xa
    s_cselect_b32 s34, s35, s34
    s_cselect_b32 s61, s43, s61
    s_min_u32 s35, s34, 0x16
    v_readlane_b32 s36, v20, s35
    v_readlane_b32 s37, v21, s35
    s_xor_b32 s28, s36, s61
    s_and_b32 s29, s37, 127
    s_mov_b32 s35, s37
    s_cmp_ge_u32 s34, 0x16
    v_mov_b32 v10, s28
    v_mov_b32 v11, s35
    ds_write_b64 v56, v[10:11]
    v_xor_b32 v56, 8, v56
    s_waitcnt lgkmcnt(0)
    s_barrier
    s_cbranch_scc1 L_tdone
L_idle:
    s_cmp_eq_u32 s29, 0
    s_cbranch_scc1 L_tick
    s_barrier
    s_sub_u32 s29, s29, 1
    s_branch L_idle
L_tdone:
    s_cmp_lg_u32 s32, 0
    s_cbranch_scc1 L_hend
    v_and_b32 v9, 15, v0
    v_lshlrev_b32 v9, 4, v9
    v_bfe_u32 v7, v0, 4, 1
    v_lshl_add_u32 v9, v7, 3, v9
    v_lshrrev_b32 v7, 5, v0
    v_lshl_add_u32 v58, v7, 2, v9
    s_barrier
L_poll:
    buffer_load_dwordx4 v[84:87], v3, s[12:15], 0 offen sc1
    buffer_load_dwordx4 v[88:91], v3, s[12:15], 0 offen offset:1024 sc1
    buffer_load_dwordx4 v[92:95], v3, s[12:15], 0 offen offset:2048 sc1
    buffer_load_dwordx4 v[96:99], v3, s[12:15], 0 offen offset:3072 sc1
    buffer_load_dwordx2 v[100:101], v2, s[12:15], 0 offen sc1
    s_add_u32 s33, s33, 0x200
    s_cbranch_scc1 L_end
    v_mov_b32 v7, 1
    v_mov_b32 v9, 1
    s_waitcnt vmcnt(4)
    v_bitop3_b32 v7, v7, v84, v64 bitop3:0x60
    v_bitop3_b32 v9, v9, v85, v65 bitop3:0x60
    v_bitop3_b32 v7, v7, v86, v66 bitop3:0x60
    v_bitop3_b32 v9, v9, v87, v67 bitop3:0x60
    v_and_b32 v84, -2, v84
    v_and_b32 v85, -2, v85
    v_and_b32 v86, -2, v86
    v_and_b32 v87, -2, v87
    s_waitcnt vmcnt(3)
    v_bitop3_b32 v7, v7, v88, v68 bitop3:0x60
    v_bitop3_b32 v9, v9, v89, v69 bitop3:0x60
    v_bitop3_b32 v7, v7, v90, v70 bitop3:0x60
    v_bitop3_b32 v9, v9, v91, v71 bitop3:0x60
    v_and_b32 v88, -2, v88
    v_and_b32 v89, -2, v89
    v_and_b32 v90, -2, v90
    v_and_b32 v91, -2, v91
    s_waitcnt vmcnt(2)
    v_bitop3_b32 v7, v7, v92, v72 bitop3:0x60
    v_bitop3_b32 v9, v9, v93, v73 bitop3:0x60
    v_bitop3_b32 v7, v7, v94, v74 bitop3:0x60
    v_bitop3_b32 v9, v9, v95, v75 bitop3:0x60
    v_and_b32 v92, -2, v92
    v_and_b32 v93, -2, v93
    v_and_b32 v94, -2, v94
    v_and_b32 v95, -2, v95
    s_waitcnt vmcnt(1)
    v_bitop3_b32 v7, v7, v96, v76 bitop3:0x60
    v_bitop3_b32 v9, v9, v97, v77 bitop3:0x60
    v_bitop3_b32 v7, v7, v98, v78 bitop3:0x60
    v_bitop3_b32 v9, v9, v99, v79 bitop3:0x60
    v_and_b32 v96, -2, v96
    v_and_b32 v97, -2, v97
    v_and_b32 v98, -2, v98
    v_and_b32 v99, -2, v99
    s_waitcnt vmcnt(0)
    v_bitop3_b32 v7, v7, v100, v80 bitop3:0x60
    v_bitop3_b32 v9, v9, v101, v81 bitop3:0x60
    v_and_b32 v100, -2, v100
    v_and_b32 v101, -2, v101
    v_and_b32 v7, v7, v9
    v_cmp_eq_u32 vcc, 0, v7
    s_cbranch_vccnz L_poll
    v_max_f32_dpp v4, v100, v100 quad_perm:[1,0,3,2] row_mask:0xf bank_mask:0xf
    s_nop 1
    v_max_f32_dpp v4, v4, v4 quad_perm:[2,3,0,1] row_mask:0xf bank_mask:0xf
    s_nop 1
    v_max_f32_dpp v4, v4, v4 row_ror:4 row_mask:0xf bank_mask:0xf
    v_sub_f32 v8, v100, v4
    v_mul_f32 v8, s30, v8
    v_exp_f32 v8, v8
    s_nop 0
    v_mul_f32 v6, v8, v101
    s_nop 0
    v_mul_f32_dpp v36, v8, v84 row_newbcast:0 row_mask:0xf bank_mask:0xf
    v_mul_f32_dpp v37, v8, v85 row_newbcast:0 row_mask:0xf bank_mask:0xf
    v_mul_f32_dpp v38, v8, v86 row_newbcast:0 row_mask:0xf bank_mask:0xf
    v_mul_f32_dpp v39, v8, v87 row_newbcast:0 row_mask:0xf bank_mask:0xf
    v_add_f32_dpp v6, v6, v6 quad_perm:[1,0,3,2] row_mask:0xf bank_mask:0xf
    v_fmac_f32_dpp v36, v8, v88 row_newbcast:2 row_mask:0xf bank_mask:0xf
    v_fmac_f32_dpp v37, v8, v89 row_newbcast:2 row_mask:0xf bank_mask:0xf
    v_fmac_f32_dpp v38, v8, v90 row_newbcast:2 row_mask:0xf bank_mask:0xf
    v_fmac_f32_dpp v39, v8, v91 row_newbcast:2 row_mask:0xf bank_mask:0xf
    v_add_f32_dpp v6, v6, v6 quad_perm:[2,3,0,1] row_mask:0xf bank_mask:0xf
    v_fmac_f32_dpp v36, v8, v92 row_newbcast:4 row_mask:0xf bank_mask:0xf
    v_fmac_f32_dpp v37, v8, v93 row_newbcast:4 row_mask:0xf bank_mask:0xf
    v_fmac_f32_dpp v38, v8, v94 row_newbcast:4 row_mask:0xf bank_mask:0xf
    v_fmac_f32_dpp v39, v8, v95 row_newbcast:4 row_mask:0xf bank_mask:0xf
    v_add_f32_dpp v6, v6, v6 row_ror:4 row_mask:0xf bank_mask:0xf
    v_fmac_f32_dpp v36, v8, v96 row_newbcast:6 row_mask:0xf bank_mask:0xf
    v_fmac_f32_dpp v37, v8, v97 row_newbcast:6 row_mask:0xf bank_mask:0xf
    v_fmac_f32_dpp v38, v8, v98 row_newbcast:6 row_mask:0xf bank_mask:0xf
    v_fmac_f32_dpp v39, v8, v99 row_newbcast:6 row_mask:0xf bank_mask:0xf
    v_rcp_f32 v7, v6
    s_nop 0
    v_permlane32_swap_b32 v36, v38
    v_permlane32_swap_b32 v37, v39
    v_fma_f32 v8, -v6, v7, 1.0
    v_fma_f32 v7, v8, v7, v7
    v_add_f32 v36, v36, v38
    v_add_f32 v37, v37, v39
    v_mul_f32 v36, v36, v7
    v_mul_f32 v37, v37, v7
    v_cvt_pk_bf16_f32 v8, v36, v37
    buffer_store_dword v8, v58, s[16:19], 0 offen
L_hend:
    s_endpgm
.section .rodata,"a"
.p2align 6
.amdhsa_kernel standalone__softmax_full_bidir__decode_kernel
  .amdhsa_next_free_vgpr 196
  .amdhsa_next_free_sgpr 64
  .amdhsa_accum_offset 196
  .amdhsa_group_segment_fixed_size 0
  .amdhsa_kernarg_size 48
  .amdhsa_user_sgpr_count 2
  .amdhsa_user_sgpr_kernarg_segment_ptr 1
  .amdhsa_system_sgpr_workgroup_id_x 1
  .amdhsa_float_denorm_mode_32 3
.end_amdhsa_kernel
```
